```python
import torch

def _softmax(x, axis=-1):
    return torch.softmax(x, dim=axis)
def _gelu(x):
    return torch.nn.functional.gelu(x, approximate="tanh")
def _silu(x):
    return torch.nn.functional.silu(x)
def _sigmoid(x):
    return torch.sigmoid(x)
def _layernorm(x, axis=-1, eps=1e-5):
    m = x.mean(dim=axis, keepdim=True)
    v = x.var(dim=axis, keepdim=True, unbiased=False)
    return (x - m) / torch.sqrt(v + eps)
def _scatter_add(tgt, idx, src, axis=0):
    return tgt.clone().index_add_(axis, idx, src)
def _segment_sum(src, seg, n):
    out = torch.zeros((n,) + src.shape[1:], dtype=src.dtype)
    return out.index_add_(0, seg, src)
def _pad(x, pw):
    flat = tuple(v for pair in reversed(pw) for v in pair)
    return torch.nn.functional.pad(x, flat)

kernel_name = 'gated_mix__mha_block__grouped_kv_mqa__prompt'

def setup_inputs():

    _w = (lambda a: (lambda t: t.to(torch.bfloat16) if t.is_floating_point() else t)(torch.as_tensor(a)))
    def _A_setup():
        B, S, D, H = 1, 2048, 512, 32
        return {
            "x": _w((lambda *s: torch.randn(*s, dtype=torch.bfloat16) * 0.05)(B, S, D)),
            "wqkv": _w((lambda *s: torch.randn(*s, dtype=torch.bfloat16) * 3.2)(D, 3 * D)),
            "wo": _w((lambda *s: torch.randn(*s, dtype=torch.bfloat16) * 1.6)(D, D)),
        }
    _A_in = _A_setup()

    def _B_setup():
        B, S, D, H = 1, 2048, 512, 32
        Dh = D // H
        return {
            "x": _w((lambda *s: torch.randn(*s, dtype=torch.bfloat16) * 0.05)(B, S, D)),
            "wq": _w((lambda *s: torch.randn(*s, dtype=torch.bfloat16) * 3.2)(D, H * Dh)),
            "wk": _w((lambda *s: torch.randn(*s, dtype=torch.bfloat16) * 3.2)(D, Dh)),
            "wv": _w((lambda *s: torch.randn(*s, dtype=torch.bfloat16) * 1.6)(D, Dh)),
            "wo": _w((lambda *s: torch.randn(*s, dtype=torch.bfloat16) * 1.6)(H * Dh, D)),
        }
    _B_in = _B_setup()

    return {
        "A_x": _A_in["x"],
        "A_wqkv": _A_in["wqkv"],
        "A_wo": _A_in["wo"],
        "B_x": _B_in["x"],
        "B_wq": _B_in["wq"],
        "B_wk": _B_in["wk"],
        "B_wv": _B_in["wv"],
        "B_wo": _B_in["wo"],
        "gate_w": _w((lambda *s: torch.randn(*s, dtype=torch.bfloat16) * 0.05)(512) * 16.0),
    }

def reference(A_x, A_wqkv, A_wo, B_x, B_wq, B_wk, B_wv, B_wo, gate_w):
    def _A_ref(x, wqkv, wo):
        B, S, D = x.shape
        H = 32
        Dh = D // H
        qkv = (lambda x, *d: x.permute(*d))((x @ wqkv).reshape(B, S, 3, H, Dh), 2, 0, 3, 1, 4)
        q, k, v = qkv[0], qkv[1], qkv[2]
        scores = torch.einsum("bhqd,bhkd->bhqk", q, k) * (Dh ** -0.5)
        p = _softmax(scores, axis=-1)
        o = torch.einsum("bhqk,bhkd->bhqd", p, v)
        return (lambda x, *d: x.permute(*d))(o, 0, 2, 1, 3).reshape(B, S, D) @ wo

    def _B_ref(x, wq, wk, wv, wo):
        B, S, D = x.shape
        H = 32
        Dh = D // H
        q = (lambda x, *d: x.permute(*d))((x @ wq).reshape(B, S, H, Dh), 0, 2, 1, 3)
        k = x @ wk
        v = x @ wv
        scores = torch.einsum("bhqd,bkd->bhqk", q, k) * (Dh ** -0.5)
        p = _softmax(scores, axis=-1)
        o = torch.einsum("bhqk,bkd->bhqd", p, v)
        return (lambda x, *d: x.permute(*d))(o, 0, 2, 1, 3).reshape(B, S, H * Dh) @ wo

    x = A_x
    g = _sigmoid((x * gate_w).sum(-1, keepdims=True))
    a = _A_ref(x, A_wqkv, A_wo)
    b = _B_ref(x, B_wq, B_wk, B_wv, B_wo)
    return g * a + (1 - g) * b
```

```asm
; @launch grid=(256,1,1) block=(512,1,1) lds=163840
.amdgcn_target "amdgcn-amd-amdhsa--gfx950"
.text
.globl gated_mix__mha_block__grouped_kv_mqa__prompt_kernel
.p2align 8
.type gated_mix__mha_block__grouped_kv_mqa__prompt_kernel,@function
gated_mix__mha_block__grouped_kv_mqa__prompt_kernel:
    s_cmp_ge_u32 s2, 256
    s_cbranch_scc1 L_end
    s_load_dwordx16 s[52:67], s[0:1], 0
    s_load_dwordx8 s[68:75], s[0:1], 64
    v_lshrrev_b32 v9, 6, v0
    v_and_b32 v1, 63, v0
    s_getpc_b64 s[84:85]
L_pc:
    v_readfirstlane_b32 s3, v9
    s_and_b32 s49, s2, 0xf8
    s_add_u32 s49, s49, 24
    v_lshlrev_b32 v10, 3, v1
    v_mov_b32 v11, s49
    v_cmp_eq_u32 vcc, 3, v1
    s_mov_b64 exec, 15
    s_nop 0
    v_cndmask_b32 v10, v10, v11, vcc
    v_add_lshl_u32 v10, v10, v9, 7
    v_min_u32 v10, L_codeend-L_pc-4, v10
    global_load_dword v251, v10, s[84:85]
    s_mov_b64 exec, -1
    s_bfe_u32 s5, s2, 0x20001
    s_bfe_u32 s49, s2, 0x20003
    s_lshl2_add_u32 s5, s5, s49
    s_and_b32 s4, s2, 1
    s_lshr_b32 s49, s2, 5
    s_lshl3_add_u32 s4, s4, s49
    s_lshl1_add_u32 s6, s5, s4
    s_and_b32 s6, s6, 6
    s_lshr_b32 s99, s3, 2
    s_mov_b32 s7, s99
    s_and_b32 s46, s3, 3
    v_lshlrev_b32 v6, 4, v1
    v_and_b32 v9, 0x30, v1
    v_lshrrev_b32 v12, 3, v1
    v_and_b32 v13, 7, v1
    v_lshrrev_b32 v14, 4, v1
    v_xor_b32 v13, v13, v14
    v_lshlrev_b32 v12, 10, v12
    v_lshl_add_u32 v246, v13, 4, v12
    v_xor_b32 v247, 64, v246
    v_add_u32 v247, 0x2000, v247
    s_lshl_b32 s80, s3, 11
    s_lshl_b32 s89, s5, 17
    s_lshr_b32 s51, s4, 1
    s_lshl_b32 s51, s51, 14
    s_add_u32 s89, s89, s51
    s_lshl_b32 s90, s3, 7
    s_add_u32 s89, s89, s90
    v_mov_b64 v[40:41], 0
    v_mov_b64 v[42:43], 0
    v_mov_b64 v[44:45], 0
    v_mov_b64 v[46:47], 0
    s_mov_b32 s10, 2097152
    s_mov_b32 s11, 0x00020000
    s_mov_b32 s18, 16384
    s_mov_b32 s19, 0x00020000
    s_mov_b32 s22, 1024
    s_mov_b32 s23, 0x00020000
    s_mov_b32 s26, 16777216
    s_mov_b32 s27, 0x00020000
    s_add_u32 m0, s80, 131072
    s_waitcnt lgkmcnt(0)
    s_mov_b64 s[24:25], s[74:75]
    s_or_b32 s50, s2, s3
    s_cbranch_scc0 L_rare_1
L_back_2:
    s_bitcmp1_b32 s4, 0
    s_cselect_b64 s[16:17], s[64:65], s[62:63]
    s_mov_b64 s[20:21], s[68:69]
    s_mov_b64 s[8:9], s[52:53]
    buffer_load_dwordx4 v6, s[16:19], s80 offen lds
    buffer_load_dwordx4 v6, s[16:19], s80 offen offset:1024 lds
    s_mov_b32 exec_lo, 0x00010001
    s_mov_b32 exec_hi, 0x00010001
    buffer_load_dwordx4 v[40:43], v9, s[20:23], s90 offen
    buffer_load_dwordx4 v[44:47], v9, s[20:23], s90 offen offset:64
    s_mov_b64 exec, -1
    s_add_u32 m0, s80, 49152
    s_nop 0
    buffer_load_dwordx4 v246, s[8:11], s89 offen lds
    s_add_u32 m0, s80, 50176
    s_nop 0
    buffer_load_dwordx4 v247, s[8:11], s89 offen lds
    s_lshr_b32 s49, s3, 1
    s_cmp_eq_u32 s49, 3
    s_movk_i32 s51, 3072
    s_cselect_b32 s50, 1024, s51
    s_cselect_b32 s51, 2, 0
    s_lshl_b32 s78, s50, 6
    s_add_u32 s81, s80, 65536
    s_cmp_lg_u32 s99, 0
    s_cbranch_scc1 L_su_q
    v_bfe_u32 v12, v1, 2, 1
    v_bfe_u32 v13, v1, 4, 1
    v_xor_b32 v12, v12, v13
    v_and_b32 v13, 3, v1
    v_lshl_add_u32 v13, v12, 2, v13
    v_lshrrev_b32 v12, 3, v1
    s_movk_i32 s79, 24576
    s_and_b32 s51, s4, 1
    s_add_u32 s51, s51, 1
    s_lshl_b32 s51, s51, 10
    s_lshr_b32 s77, s4, 1
    s_lshl_b32 s77, s77, 7
    s_add_u32 s77, s77, s51
    s_mul_i32 s91, s3, 49152
    s_branch L_su_j
L_su_q:
    v_lshrrev_b32 v12, 2, v1
    v_and_b32 v13, 3, v1
    v_xor_b32 v13, s51, v13
    s_lshl_b32 s79, s50, 4
    s_lshl_b32 s77, s4, 6
    s_and_b32 s51, s3, 1
    s_mul_i32 s91, s51, s79
    s_lshl_b32 s91, s91, 1
L_su_j:
    s_add_u32 s77, s77, s91
    v_mul_u32_u24 v12, s50, v12
    v_lshl_add_u32 v248, v13, 4, v12
    s_lshl_b32 s76, s5, 17
    s_lshl_b32 s51, s3, 14
    s_add_u32 s76, s76, s51
    s_lshl_b32 s82, s6, 7
    s_mul_i32 s83, s6, s78
    s_and_b32 s6, s3, 3
    s_cmp_eq_u32 s49, 3
    s_cselect_b64 s[12:13], s[60:61], s[54:55]
    s_mov_b32 s14, 1572864
    s_cselect_b32 s14, 524288, s14
    s_mov_b32 s15, 0x00020000
    s_mov_b64 s[28:29], s[72:73]
    s_mov_b32 s30, 256
    s_mov_b32 s31, 0x00020000
    s_mov_b32 s44, 0x0000ffff
    s_mov_b32 s45, 0x0000ffff
    s_mov_b32 s48, 1048576
    s_mov_b32 s47, 0
    v_mov_b32 v250, 0
    s_barrier
    v_lshrrev_b32 v12, 4, v1
    v_bfe_u32 v13, v1, 2, 2
    v_lshl_add_u32 v12, v12, 3, v13
    v_and_b32 v13, 3, v1
    v_lshlrev_b32 v13, 3, v13
    v_lshl_add_u32 v12, v12, 5, v13
    s_add_u32 s50, s80, 131072
    v_add_u32 v14, s50, v12
    s_lshl_b32 s50, s3, 10
    s_add_u32 s50, s50, 147456
    v_add_u32 v15, s50, v6
    s_lshl_b32 s50, s3, 8
    s_add_u32 s50, s50, 155648
    v_lshlrev_b32 v13, 2, v1
    v_add_u32 v13, s50, v13
    v_and_b32 v8, 15, v1
    v_lshrrev_b32 v9, 4, v1
    v_bfe_u32 v10, v1, 1, 3
    v_xor_b32 v9, v9, v10
    v_lshlrev_b32 v9, 4, v9
    v_lshl_add_u32 v8, v8, 7, v9
    s_add_u32 s50, s80, 49152
    v_add_u32 v8, s50, v8
    v_xor_b32 v9, 64, v8
    s_add_u32 m0, s80, 0
    s_add_u32 s93, s76, s82
    buffer_load_dwordx4 v246, s[8:11], s93 offen lds
    s_add_u32 m0, s80, 1024
    s_add_u32 s91, s77, s83
    buffer_load_dwordx4 v247, s[8:11], s93 offen lds
    s_add_u32 m0, s81, 0
    s_add_u32 s93, s91, s79
    buffer_load_dwordx4 v248, s[12:15], s91 offen lds
    s_add_u32 m0, s81, 1024
    s_add_u32 s83, s83, s78
    buffer_load_dwordx4 v248, s[12:15], s93 offen lds
    s_add_u32 s82, s82, 128
    s_and_b32 s82, s82, 1023
    s_cselect_b32 s83, s83, 0
    s_or_b32 s50, s2, s3
    s_cbranch_scc0 L_rare_3
L_back_4:
    s_waitcnt vmcnt(4)
    s_waitcnt lgkmcnt(0)
    ds_read_b128 v[16:19], v8
    ds_read_b128 v[20:23], v9
    ds_read_b64_tr_b16 v[24:25], v14 offset:0
    ds_read_b64_tr_b16 v[26:27], v14 offset:128
    ds_read_b64_tr_b16 v[28:29], v14 offset:1024
    ds_read_b64_tr_b16 v[30:31], v14 offset:1152
    s_waitcnt lgkmcnt(0)
    s_bitcmp1_b32 s4, 0
    s_cbranch_scc1 L_ev_7
    v_mfma_f32_16x16x32_bf16 v[32:35], v[24:27], v[16:19], 0
    v_mfma_f32_16x16x32_bf16 v[36:39], v[40:43], v[16:19], 0
    v_mfma_f32_16x16x32_bf16 v[32:35], v[28:31], v[20:23], v[32:35]
    v_mfma_f32_16x16x32_bf16 v[36:39], v[44:47], v[20:23], v[36:39]
    s_branch L_ee_8
L_ev_7:
    v_mfma_f32_16x16x32_bf16 v[32:35], v[16:19], v[24:27], 0
    v_mov_b32 v36, 0
    v_mfma_f32_16x16x32_bf16 v[32:35], v[20:23], v[28:31], v[32:35]
L_ee_8:
    s_nop 7
    ds_write_b128 v15, v[32:35]
    ds_write_b32 v13, v36
    s_waitcnt lgkmcnt(0)
    s_barrier
    s_add_u32 m0, s80, 16384
    s_add_u32 s93, s76, s82
    buffer_load_dwordx4 v246, s[8:11], s93 offen lds
    s_add_u32 m0, s80, 17408
    s_add_u32 s91, s77, s83
    buffer_load_dwordx4 v247, s[8:11], s93 offen lds
    s_add_u32 m0, s81, 16384
    s_add_u32 s93, s91, s79
    buffer_load_dwordx4 v248, s[12:15], s91 offen lds
    s_add_u32 m0, s81, 17408
    s_add_u32 s83, s83, s78
    buffer_load_dwordx4 v248, s[12:15], s93 offen lds
    s_add_u32 s82, s82, 128
    s_and_b32 s82, s82, 1023
    s_cselect_b32 s83, s83, 0
    s_cmp_eq_u32 s3, 0
    s_cbranch_scc1 L_rare_9
L_back_10:
    v_and_b32 v10, 31, v1
    v_lshrrev_b32 v11, 5, v1
    v_bfe_u32 v12, v1, 1, 3
    v_xor_b32 v12, v12, v11
    v_lshlrev_b32 v12, 4, v12
    v_lshl_add_u32 v12, v10, 7, v12
    s_lshl_b32 s50, s46, 12
    v_add_u32 v240, s50, v12
    v_xor_b32 v241, 32, v240
    v_xor_b32 v242, 64, v240
    v_xor_b32 v243, 0x60, v240
    v_bfe_u32 v12, v1, 2, 2
    v_and_b32 v13, 3, v1
    v_lshlrev_b32 v13, 3, v13
    v_lshl_add_u32 v13, v12, 6, v13
    v_lshl_add_u32 v13, v11, 9, v13
    v_bfe_u32 v14, v1, 4, 1
    v_bfe_u32 v15, v1, 3, 1
    v_xor_b32 v15, s7, v15
    v_lshlrev_b32 v15, 6, v15
    v_lshl_add_u32 v15, v12, 7, v15
    v_lshl_add_u32 v15, v11, 10, v15
    v_lshl_add_u32 v15, v14, 5, v15
    v_and_b32 v10, 3, v1
    v_lshl_add_u32 v15, v10, 3, v15
    v_add_u32 v244, 65536, v15
    v_xor_b32 v12, s7, v14
    v_lshl_add_u32 v13, v12, 5, v13
    v_lshl_add_u32 v13, v14, 12, v13
    v_add_u32 v245, 73728, v13
    s_bitcmp1_b32 s4, 0
    s_cbranch_scc1 L_p1b
L_p1a:
    s_cmp_eq_u32 s3, 0
    s_cbranch_scc1 L_wa_13
    s_waitcnt vmcnt(4)
L_wa_13:
    s_waitcnt vmcnt(5)
    s_waitcnt lgkmcnt(0)
    s_barrier
    s_cmp_eq_u32 s3, 0
    s_cbranch_scc1 L_rare_15
L_back_16:
    ds_read_b128 v[176:179], v240 offset:0
    ds_read_b64_tr_b16 v[180:181], v244 offset:0
    ds_read_b64_tr_b16 v[182:183], v244 offset:512
    ds_read_b64_tr_b16 v[184:185], v245 offset:0
    ds_read_b64_tr_b16 v[186:187], v245 offset:256
    ds_read_b128 v[188:191], v241 offset:0
    ds_read_b64_tr_b16 v[192:193], v244 offset:2048
    ds_read_b64_tr_b16 v[194:195], v244 offset:2560
    ds_read_b64_tr_b16 v[196:197], v245 offset:1024
    ds_read_b64_tr_b16 v[198:199], v245 offset:1280
    s_add_u32 m0, s80, 32768
    s_add_u32 s93, s76, s82
    buffer_load_dwordx4 v246, s[8:11], s93 offen lds
    s_add_u32 m0, s80, 33792
    s_add_u32 s91, s77, s83
    buffer_load_dwordx4 v247, s[8:11], s93 offen lds
    s_add_u32 m0, s81, 32768
    s_add_u32 s93, s91, s79
    buffer_load_dwordx4 v248, s[12:15], s91 offen lds
    ds_read_b128 v[200:203], v242 offset:0
    ds_read_b64_tr_b16 v[204:205], v244 offset:4096
    ds_read_b64_tr_b16 v[206:207], v244 offset:4608
    ds_read_b64_tr_b16 v[208:209], v245 offset:2048
    ds_read_b64_tr_b16 v[210:211], v245 offset:2304
    s_waitcnt lgkmcnt(10)
    v_mfma_f32_32x32x16_bf16 v[144:159], v[180:183], v[176:179], 0
    v_mfma_f32_32x32x16_bf16 v[160:175], v[184:187], v[176:179], 0
    s_add_u32 m0, s81, 33792
    s_add_u32 s83, s83, s78
    buffer_load_dwordx4 v248, s[12:15], s93 offen lds
    s_add_u32 s82, s82, 128
    s_and_b32 s82, s82, 1023
    s_cselect_b32 s83, s83, 0
    ds_read_b128 v[212:215], v243 offset:0
    ds_read_b64_tr_b16 v[216:217], v244 offset:6144
    ds_read_b64_tr_b16 v[218:219], v244 offset:6656
    ds_read_b64_tr_b16 v[220:221], v245 offset:3072
    ds_read_b64_tr_b16 v[222:223], v245 offset:3328
    s_waitcnt lgkmcnt(10)
    v_mfma_f32_32x32x16_bf16 v[144:159], v[192:195], v[188:191], v[144:159]
    v_mfma_f32_32x32x16_bf16 v[160:175], v[196:199], v[188:191], v[160:175]
    s_waitcnt lgkmcnt(5)
    v_mfma_f32_32x32x16_bf16 v[144:159], v[204:207], v[200:203], v[144:159]
    v_mfma_f32_32x32x16_bf16 v[160:175], v[208:211], v[200:203], v[160:175]
    v_mov_b32 v2, 0xdddddddd
    v_lshrrev_b32 v8, 5, v1
    v_and_b32 v9, 15, v1
    v_lshl_add_u32 v8, v8, 4, v9
    v_lshlrev_b32 v7, 4, v8
    v_and_b32 v8, 31, v1
    v_cmp_eq_u32 vcc, 16, v8
    v_mov_b32 v9, 0x3f803f80
    v_add_u32 v3, 131072, v6
    v_cndmask_b32 v9, 0, v9, vcc
    v_add_u32 v4, 139264, v7
    v_mov_b32 v96, v9
    v_mov_b32 v97, v9
    v_mov_b32 v98, v9
    v_mov_b32 v99, v9
    v_mov_b32 v100, v9
    v_mov_b32 v101, v9
    v_mov_b32 v102, v9
    v_mov_b32 v103, v9
    v_mov_b32 v104, v9
    v_mov_b32 v105, v9
    v_mov_b32 v106, v9
    v_mov_b32 v107, v9
    v_mov_b32 v108, v9
    v_mov_b32 v109, v9
    v_mov_b32 v110, v9
    v_mov_b32 v111, v9
    v_mov_b64 v[112:113], 0
    v_mov_b64 v[114:115], 0
    v_mov_b64 v[116:117], 0
    v_mov_b64 v[118:119], 0
    v_mov_b64 v[120:121], 0
    v_mov_b64 v[122:123], 0
    v_mov_b64 v[124:125], 0
    v_mov_b64 v[126:127], 0
    v_mov_b64 v[48:49], 0
    v_mov_b64 v[50:51], 0
    v_mov_b64 v[52:53], 0
    v_mov_b64 v[54:55], 0
    v_mov_b64 v[56:57], 0
    v_mov_b64 v[58:59], 0
    v_mov_b64 v[60:61], 0
    v_mov_b64 v[62:63], 0
    s_lshl1_add_u32 s50, s4, s99
    s_lshl_b32 s89, s50, 17
    s_lshl_b32 s51, s6, 12
    s_add_u32 s89, s89, s51
    s_lshl1_add_u32 s50, s4, s7
    s_lshl_b32 s51, s5, 2
    s_add_u32 s51, s51, s46
    s_lshl_b32 s51, s51, 5
    s_add_u32 s51, s51, s50
    s_lshl_b32 s90, s51, 10
    s_and_b32 s50, s4, 14
    s_add_u32 s50, s50, s7
    s_lshl_b32 s50, s50, 18
    s_lshr_b32 s51, s5, 1
    s_lshl_b32 s51, s51, 14
    s_add_u32 s50, s50, s51
    s_and_b32 s51, s5, 1
    s_lshl_b32 s51, s51, 2
    s_add_u32 s51, s51, s46
    s_lshl_b32 s51, s51, 10
    s_add_u32 s87, s50, s51
    s_mov_b32 s100, 0x3eb8aa3b
    s_mov_b32 s101, 0x3eb8aa3b
    s_bitcmp1_b32 s4, 0
    s_cbranch_scc1 L_ka_17
    v_and_b32 v8, 0x33, v1
    v_bfe_u32 v9, v1, 2, 1
    v_lshl_or_b32 v8, v9, 3, v8
    v_bfe_u32 v9, v1, 3, 1
    v_lshl_or_b32 v8, v9, 2, v8
    v_lshlrev_b32 v249, 4, v8
    s_add_u32 s98, s87, 131072
    s_branch L_kb_18
L_ka_17:
    v_bfe_u32 v8, v1, 4, 1
    v_lshlrev_b32 v8, 17, v8
    v_lshrrev_b32 v9, 5, v1
    v_and_b32 v10, 15, v1
    v_lshl_add_u32 v9, v9, 4, v10
    v_lshl_add_u32 v249, v9, 4, v8
    s_add_u32 s87, s87, 8192
    s_add_u32 s98, s87, 512
L_kb_18:
    s_cmp_eq_u32 s3, 0
    s_cbranch_scc1 L_wa_19
    s_waitcnt vmcnt(4)
L_wa_19:
    s_waitcnt vmcnt(6)
    s_waitcnt lgkmcnt(0)
    s_barrier
    ds_read_b128 v[176:179], v240 offset:16384
    ds_read_b64_tr_b16 v[180:181], v244 offset:16384
    ds_read_b64_tr_b16 v[182:183], v244 offset:16896
    ds_read_b64_tr_b16 v[184:185], v245 offset:16384
    ds_read_b64_tr_b16 v[186:187], v245 offset:16640
    ds_read_b128 v[188:191], v241 offset:16384
    ds_read_b64_tr_b16 v[192:193], v244 offset:18432
    ds_read_b64_tr_b16 v[194:195], v244 offset:18944
    ds_read_b64_tr_b16 v[196:197], v245 offset:17408
    ds_read_b64_tr_b16 v[198:199], v245 offset:17664
    s_add_u32 m0, s80, 49152
    s_add_u32 s93, s76, s82
    buffer_load_dwordx4 v246, s[8:11], s93 offen lds
    v_mfma_f32_32x32x16_bf16 v[144:159], v[216:219], v[212:215], v[144:159]
    v_mfma_f32_32x32x16_bf16 v[160:175], v[220:223], v[212:215], v[160:175]
    s_add_u32 m0, s80, 50176
    s_add_u32 s91, s77, s83
    buffer_load_dwordx4 v247, s[8:11], s93 offen lds
    s_add_u32 m0, s81, 49152
    s_add_u32 s93, s91, s79
    buffer_load_dwordx4 v248, s[12:15], s91 offen lds
    ds_read_b128 v[200:203], v242 offset:16384
    ds_read_b64_tr_b16 v[204:205], v244 offset:20480
    ds_read_b64_tr_b16 v[206:207], v244 offset:20992
    ds_read_b64_tr_b16 v[208:209], v245 offset:18432
    ds_read_b64_tr_b16 v[210:211], v245 offset:18688
    s_waitcnt lgkmcnt(10)
    v_mfma_f32_32x32x16_bf16 v[144:159], v[180:183], v[176:179], v[144:159]
    v_mfma_f32_32x32x16_bf16 v[160:175], v[184:187], v[176:179], v[160:175]
    s_add_u32 m0, s81, 50176
    s_add_u32 s83, s83, s78
    buffer_load_dwordx4 v248, s[12:15], s93 offen lds
    s_add_u32 s82, s82, 128
    s_and_b32 s82, s82, 1023
    s_cselect_b32 s83, s83, 0
    ds_read_b128 v[212:215], v243 offset:16384
    ds_read_b64_tr_b16 v[216:217], v244 offset:22528
    ds_read_b64_tr_b16 v[218:219], v244 offset:23040
    ds_read_b64_tr_b16 v[220:221], v245 offset:19456
    ds_read_b64_tr_b16 v[222:223], v245 offset:19712
    s_waitcnt lgkmcnt(10)
    v_mfma_f32_32x32x16_bf16 v[144:159], v[192:195], v[188:191], v[144:159]
    v_mfma_f32_32x32x16_bf16 v[160:175], v[196:199], v[188:191], v[160:175]
    s_waitcnt lgkmcnt(5)
    v_mfma_f32_32x32x16_bf16 v[144:159], v[204:207], v[200:203], v[144:159]
    v_mfma_f32_32x32x16_bf16 v[160:175], v[208:211], v[200:203], v[160:175]
    s_mov_b64 s[32:33], s[70:71]
    s_mov_b32 s34, 2097152
    s_mov_b32 s35, 0x00020000
    s_mov_b64 s[36:37], s[56:57]
    s_mov_b32 s38, 524288
    s_mov_b32 s39, 0x00020000
    s_mov_b64 s[40:41], s[66:67]
    s_mov_b32 s42, 524288
    s_mov_b32 s43, 0x00020000
    v_lshrrev_b32 v8, 3, v1
    v_bfe_u32 v9, v1, 2, 1
    v_bfe_u32 v10, v1, 4, 1
    v_xor_b32 v9, v9, v10
    v_lshlrev_b32 v9, 6, v9
    v_lshl_add_u32 v9, v8, 10, v9
    v_and_b32 v11, 3, v1
    v_lshl_add_u32 v224, v11, 4, v9
    v_lshrrev_b32 v8, 5, v1
    v_bfe_u32 v9, v1, 2, 2
    v_lshl_add_u32 v8, v8, 2, v9
    v_lshlrev_b32 v8, 7, v8
    v_bfe_u32 v9, v1, 3, 1
    v_lshl_add_u32 v8, v9, 6, v8
    v_lshl_add_u32 v8, v10, 5, v8
    v_lshl_add_u32 v8, v11, 3, v8
    s_lshl_b32 s50, s6, 13
    s_add_u32 s50, s50, 32768
    s_lshr_b32 s51, s4, 3
    s_lshl_b32 s51, s51, 15
    s_add_u32 s50, s50, s51
    v_add_u32 v230, s50, v8
    v_xor_b32 v231, 64, v230
    s_lshl_b32 s51, s51, 1
    s_sub_u32 s50, s50, s51
    s_add_u32 s50, s50, 32768
    v_add_u32 v228, s50, v8
    v_xor_b32 v229, 64, v228
    s_waitcnt vmcnt(4)
    s_cmp_eq_u32 s3, 0
    s_cbranch_scc1 L_rare_21
L_back_22:
    s_waitcnt lgkmcnt(0)
    s_barrier
    ds_read_b128 v[176:179], v240 offset:32768
    ds_read_b64_tr_b16 v[180:181], v244 offset:32768
    ds_read_b64_tr_b16 v[182:183], v244 offset:33280
    ds_read_b64_tr_b16 v[184:185], v245 offset:32768
    ds_read_b64_tr_b16 v[186:187], v245 offset:33024
    ds_read_b128 v[188:191], v241 offset:32768
    ds_read_b64_tr_b16 v[192:193], v244 offset:34816
    ds_read_b64_tr_b16 v[194:195], v244 offset:35328
    ds_read_b64_tr_b16 v[196:197], v245 offset:33792
    ds_read_b64_tr_b16 v[198:199], v245 offset:34048
    s_add_u32 m0, s80, 0
    s_add_u32 s93, s76, s82
    buffer_load_dwordx4 v246, s[8:11], s93 offen lds
    v_mfma_f32_32x32x16_bf16 v[144:159], v[216:219], v[212:215], v[144:159]
    v_mfma_f32_32x32x16_bf16 v[160:175], v[220:223], v[212:215], v[160:175]
    s_add_u32 m0, s80, 1024
    s_add_u32 s91, s77, s83
    buffer_load_dwordx4 v247, s[8:11], s93 offen lds
    s_add_u32 m0, s81, 0
    s_add_u32 s93, s91, s79
    buffer_load_dwordx4 v248, s[12:15], s91 offen lds
    ds_read_b128 v[200:203], v242 offset:32768
    ds_read_b64_tr_b16 v[204:205], v244 offset:36864
    ds_read_b64_tr_b16 v[206:207], v244 offset:37376
    ds_read_b64_tr_b16 v[208:209], v245 offset:34816
    ds_read_b64_tr_b16 v[210:211], v245 offset:35072
    s_waitcnt lgkmcnt(10)
    v_mfma_f32_32x32x16_bf16 v[144:159], v[180:183], v[176:179], v[144:159]
    v_mfma_f32_32x32x16_bf16 v[160:175], v[184:187], v[176:179], v[160:175]
    s_add_u32 m0, s81, 1024
    s_add_u32 s83, s83, s78
    buffer_load_dwordx4 v248, s[12:15], s93 offen lds
    s_add_u32 s82, s82, 128
    s_and_b32 s82, s82, 1023
    s_cselect_b32 s83, s83, 0
    ds_read_b128 v[212:215], v243 offset:32768
    ds_read_b64_tr_b16 v[216:217], v244 offset:38912
    ds_read_b64_tr_b16 v[218:219], v244 offset:39424
    ds_read_b64_tr_b16 v[220:221], v245 offset:35840
    ds_read_b64_tr_b16 v[222:223], v245 offset:36096
    s_waitcnt lgkmcnt(10)
    v_mfma_f32_32x32x16_bf16 v[144:159], v[192:195], v[188:191], v[144:159]
    v_mfma_f32_32x32x16_bf16 v[160:175], v[196:199], v[188:191], v[160:175]
    s_waitcnt lgkmcnt(5)
    v_mfma_f32_32x32x16_bf16 v[144:159], v[204:207], v[200:203], v[144:159]
    v_mfma_f32_32x32x16_bf16 v[160:175], v[208:211], v[200:203], v[160:175]
    s_waitcnt vmcnt(4)
    s_waitcnt lgkmcnt(0)
    s_barrier
    ds_read_b128 v[176:179], v240 offset:49152
    ds_read_b64_tr_b16 v[180:181], v244 offset:49152
    ds_read_b64_tr_b16 v[182:183], v244 offset:49664
    ds_read_b64_tr_b16 v[184:185], v245 offset:49152
    ds_read_b64_tr_b16 v[186:187], v245 offset:49408
    ds_read_b128 v[188:191], v241 offset:49152
    ds_read_b64_tr_b16 v[192:193], v244 offset:51200
    ds_read_b64_tr_b16 v[194:195], v244 offset:51712
    ds_read_b64_tr_b16 v[196:197], v245 offset:50176
    ds_read_b64_tr_b16 v[198:199], v245 offset:50432
    s_add_u32 m0, s80, 16384
    s_add_u32 s93, s76, s82
    buffer_load_dwordx4 v246, s[8:11], s93 offen lds
    v_mfma_f32_32x32x16_bf16 v[144:159], v[216:219], v[212:215], v[144:159]
    v_mfma_f32_32x32x16_bf16 v[160:175], v[220:223], v[212:215], v[160:175]
    s_add_u32 m0, s80, 17408
    s_add_u32 s91, s77, s83
    buffer_load_dwordx4 v247, s[8:11], s93 offen lds
    s_add_u32 m0, s81, 16384
    s_add_u32 s93, s91, s79
    buffer_load_dwordx4 v248, s[12:15], s91 offen lds
    ds_read_b128 v[200:203], v242 offset:49152
    ds_read_b64_tr_b16 v[204:205], v244 offset:53248
    ds_read_b64_tr_b16 v[206:207], v244 offset:53760
    ds_read_b64_tr_b16 v[208:209], v245 offset:51200
    ds_read_b64_tr_b16 v[210:211], v245 offset:51456
    s_waitcnt lgkmcnt(10)
    v_mfma_f32_32x32x16_bf16 v[144:159], v[180:183], v[176:179], v[144:159]
    v_mfma_f32_32x32x16_bf16 v[160:175], v[184:187], v[176:179], v[160:175]
    s_add_u32 m0, s81, 17408
    s_add_u32 s83, s83, s78
    buffer_load_dwordx4 v248, s[12:15], s93 offen lds
    s_add_u32 s82, s82, 128
    s_and_b32 s82, s82, 1023
    s_cselect_b32 s83, s83, 0
    ds_read_b128 v[212:215], v243 offset:49152
    ds_read_b64_tr_b16 v[216:217], v244 offset:55296
    ds_read_b64_tr_b16 v[218:219], v244 offset:55808
    ds_read_b64_tr_b16 v[220:221], v245 offset:52224
    ds_read_b64_tr_b16 v[222:223], v245 offset:52480
    s_waitcnt lgkmcnt(10)
    v_mfma_f32_32x32x16_bf16 v[144:159], v[192:195], v[188:191], v[144:159]
    v_mfma_f32_32x32x16_bf16 v[160:175], v[196:199], v[188:191], v[160:175]
    s_waitcnt lgkmcnt(5)
    v_mfma_f32_32x32x16_bf16 v[144:159], v[204:207], v[200:203], v[144:159]
    v_mfma_f32_32x32x16_bf16 v[160:175], v[208:211], v[200:203], v[160:175]
    s_waitcnt vmcnt(4)
    s_waitcnt lgkmcnt(0)
    s_barrier
    ds_read_b128 v[176:179], v240 offset:0
    ds_read_b64_tr_b16 v[180:181], v244 offset:0
    ds_read_b64_tr_b16 v[182:183], v244 offset:512
    ds_read_b64_tr_b16 v[184:185], v245 offset:0
    ds_read_b64_tr_b16 v[186:187], v245 offset:256
    ds_read_b128 v[188:191], v241 offset:0
    ds_read_b64_tr_b16 v[192:193], v244 offset:2048
    ds_read_b64_tr_b16 v[194:195], v244 offset:2560
    ds_read_b64_tr_b16 v[196:197], v245 offset:1024
    ds_read_b64_tr_b16 v[198:199], v245 offset:1280
    s_add_u32 m0, s80, 32768
    s_add_u32 s93, s76, s82
    buffer_load_dwordx4 v246, s[8:11], s93 offen lds
    v_mfma_f32_32x32x16_bf16 v[144:159], v[216:219], v[212:215], v[144:159]
    v_mfma_f32_32x32x16_bf16 v[160:175], v[220:223], v[212:215], v[160:175]
    s_add_u32 m0, s80, 33792
    s_add_u32 s91, s77, s83
    buffer_load_dwordx4 v247, s[8:11], s93 offen lds
    s_add_u32 m0, s81, 32768
    s_add_u32 s93, s91, s79
    buffer_load_dwordx4 v248, s[12:15], s91 offen lds
    ds_read_b128 v[200:203], v242 offset:0
    ds_read_b64_tr_b16 v[204:205], v244 offset:4096
    ds_read_b64_tr_b16 v[206:207], v244 offset:4608
    ds_read_b64_tr_b16 v[208:209], v245 offset:2048
    ds_read_b64_tr_b16 v[210:211], v245 offset:2304
    s_waitcnt lgkmcnt(10)
    v_mfma_f32_32x32x16_bf16 v[144:159], v[180:183], v[176:179], v[144:159]
    v_mfma_f32_32x32x16_bf16 v[160:175], v[184:187], v[176:179], v[160:175]
    s_add_u32 m0, s81, 33792
    s_add_u32 s83, s83, s78
    buffer_load_dwordx4 v248, s[12:15], s93 offen lds
    s_add_u32 s82, s82, 128
    s_and_b32 s82, s82, 1023
    s_cselect_b32 s83, s83, 0
    ds_read_b128 v[212:215], v243 offset:0
    ds_read_b64_tr_b16 v[216:217], v244 offset:6144
    ds_read_b64_tr_b16 v[218:219], v244 offset:6656
    ds_read_b64_tr_b16 v[220:221], v245 offset:3072
    ds_read_b64_tr_b16 v[222:223], v245 offset:3328
    s_waitcnt lgkmcnt(10)
    v_mfma_f32_32x32x16_bf16 v[144:159], v[192:195], v[188:191], v[144:159]
    v_mfma_f32_32x32x16_bf16 v[160:175], v[196:199], v[188:191], v[160:175]
    s_waitcnt lgkmcnt(5)
    v_mfma_f32_32x32x16_bf16 v[144:159], v[204:207], v[200:203], v[144:159]
    v_mfma_f32_32x32x16_bf16 v[160:175], v[208:211], v[200:203], v[160:175]
    s_waitcnt vmcnt(4)
    s_waitcnt lgkmcnt(0)
    s_barrier
    s_cmp_eq_u32 s3, 0
    s_cbranch_scc1 L_rare_25
L_back_26:
    ds_read_b128 v[176:179], v240 offset:16384
    ds_read_b64_tr_b16 v[180:181], v244 offset:16384
    ds_read_b64_tr_b16 v[182:183], v244 offset:16896
    ds_read_b64_tr_b16 v[184:185], v245 offset:16384
    ds_read_b64_tr_b16 v[186:187], v245 offset:16640
    ds_read_b128 v[188:191], v241 offset:16384
    ds_read_b64_tr_b16 v[192:193], v244 offset:18432
    ds_read_b64_tr_b16 v[194:195], v244 offset:18944
    ds_read_b64_tr_b16 v[196:197], v245 offset:17408
    ds_read_b64_tr_b16 v[198:199], v245 offset:17664
    s_add_u32 m0, s80, 49152
    s_add_u32 s93, s76, s82
    buffer_load_dwordx4 v246, s[8:11], s93 offen lds
    v_mfma_f32_32x32x16_bf16 v[144:159], v[216:219], v[212:215], v[144:159]
    v_mfma_f32_32x32x16_bf16 v[160:175], v[220:223], v[212:215], v[160:175]
    s_add_u32 m0, s80, 50176
    s_add_u32 s91, s77, s83
    buffer_load_dwordx4 v247, s[8:11], s93 offen lds
    s_add_u32 m0, s81, 49152
    s_add_u32 s93, s91, s79
    buffer_load_dwordx4 v248, s[12:15], s91 offen lds
    ds_read_b128 v[200:203], v242 offset:16384
    ds_read_b64_tr_b16 v[204:205], v244 offset:20480
    ds_read_b64_tr_b16 v[206:207], v244 offset:20992
    ds_read_b64_tr_b16 v[208:209], v245 offset:18432
    ds_read_b64_tr_b16 v[210:211], v245 offset:18688
    s_waitcnt lgkmcnt(10)
    v_mfma_f32_32x32x16_bf16 v[144:159], v[180:183], v[176:179], v[144:159]
    v_mfma_f32_32x32x16_bf16 v[160:175], v[184:187], v[176:179], v[160:175]
    s_add_u32 m0, s81, 50176
    s_add_u32 s83, s83, s78
    buffer_load_dwordx4 v248, s[12:15], s93 offen lds
    ds_read_b128 v[212:215], v243 offset:16384
    ds_read_b64_tr_b16 v[216:217], v244 offset:22528
    ds_read_b64_tr_b16 v[218:219], v244 offset:23040
    ds_read_b64_tr_b16 v[220:221], v245 offset:19456
    ds_read_b64_tr_b16 v[222:223], v245 offset:19712
    s_waitcnt lgkmcnt(10)
    v_mfma_f32_32x32x16_bf16 v[144:159], v[192:195], v[188:191], v[144:159]
    v_mfma_f32_32x32x16_bf16 v[160:175], v[196:199], v[188:191], v[160:175]
    s_waitcnt lgkmcnt(5)
    v_mfma_f32_32x32x16_bf16 v[144:159], v[204:207], v[200:203], v[144:159]
    v_mfma_f32_32x32x16_bf16 v[160:175], v[208:211], v[200:203], v[160:175]
    s_waitcnt vmcnt(4)
    s_cmp_eq_u32 s3, 0
    s_cbranch_scc1 L_rare_27
L_back_28:
    s_waitcnt lgkmcnt(0)
    s_barrier
    ds_read_b128 v[176:179], v240 offset:32768
    ds_read_b64_tr_b16 v[180:181], v244 offset:32768
    ds_read_b64_tr_b16 v[182:183], v244 offset:33280
    ds_read_b64_tr_b16 v[184:185], v245 offset:32768
    ds_read_b64_tr_b16 v[186:187], v245 offset:33024
    ds_read_b128 v[188:191], v241 offset:32768
    ds_read_b64_tr_b16 v[192:193], v244 offset:34816
    ds_read_b64_tr_b16 v[194:195], v244 offset:35328
    ds_read_b64_tr_b16 v[196:197], v245 offset:33792
    ds_read_b64_tr_b16 v[198:199], v245 offset:34048
    s_lshl_b32 s51, s3, 12
    s_add_u32 m0, s51, 131072
    s_add_u32 s93, s51, 4194304
    buffer_load_dwordx4 v6, s[24:27], s93 offen offset:0 sc1 lds
    v_mfma_f32_32x32x16_bf16 v[144:159], v[216:219], v[212:215], v[144:159]
    v_mfma_f32_32x32x16_bf16 v[160:175], v[220:223], v[212:215], v[160:175]
    buffer_load_dwordx4 v6, s[24:27], s93 offen offset:1024 sc1 lds
    buffer_load_dwordx4 v6, s[24:27], s93 offen offset:2048 sc1 lds
    ds_read_b128 v[200:203], v242 offset:32768
    ds_read_b64_tr_b16 v[204:205], v244 offset:36864
    ds_read_b64_tr_b16 v[206:207], v244 offset:37376
    ds_read_b64_tr_b16 v[208:209], v245 offset:34816
    ds_read_b64_tr_b16 v[210:211], v245 offset:35072
    s_waitcnt lgkmcnt(10)
    v_mfma_f32_32x32x16_bf16 v[144:159], v[180:183], v[176:179], v[144:159]
    v_mfma_f32_32x32x16_bf16 v[160:175], v[184:187], v[176:179], v[160:175]
    buffer_load_dwordx4 v6, s[24:27], s93 offen offset:3072 sc1 lds
    ds_read_b128 v[212:215], v243 offset:32768
    ds_read_b64_tr_b16 v[216:217], v244 offset:38912
    ds_read_b64_tr_b16 v[218:219], v244 offset:39424
    ds_read_b64_tr_b16 v[220:221], v245 offset:35840
    ds_read_b64_tr_b16 v[222:223], v245 offset:36096
    s_waitcnt lgkmcnt(10)
    v_mfma_f32_32x32x16_bf16 v[144:159], v[192:195], v[188:191], v[144:159]
    v_mfma_f32_32x32x16_bf16 v[160:175], v[196:199], v[188:191], v[160:175]
    s_waitcnt lgkmcnt(5)
    v_mfma_f32_32x32x16_bf16 v[144:159], v[204:207], v[200:203], v[144:159]
    v_mfma_f32_32x32x16_bf16 v[160:175], v[208:211], v[200:203], v[160:175]
    s_waitcnt vmcnt(4)
    s_waitcnt lgkmcnt(0)
    s_barrier
    ds_read_b128 v[176:179], v240 offset:49152
    ds_read_b64_tr_b16 v[180:181], v244 offset:49152
    ds_read_b64_tr_b16 v[182:183], v244 offset:49664
    ds_read_b64_tr_b16 v[184:185], v245 offset:49152
    ds_read_b64_tr_b16 v[186:187], v245 offset:49408
    ds_read_b128 v[188:191], v241 offset:49152
    ds_read_b64_tr_b16 v[192:193], v244 offset:51200
    ds_read_b64_tr_b16 v[194:195], v244 offset:51712
    ds_read_b64_tr_b16 v[196:197], v245 offset:50176
    ds_read_b64_tr_b16 v[198:199], v245 offset:50432
    v_mfma_f32_32x32x16_bf16 v[144:159], v[216:219], v[212:215], v[144:159]
    v_mfma_f32_32x32x16_bf16 v[160:175], v[220:223], v[212:215], v[160:175]
    ds_read_b128 v[200:203], v242 offset:49152
    ds_read_b64_tr_b16 v[204:205], v244 offset:53248
    ds_read_b64_tr_b16 v[206:207], v244 offset:53760
    ds_read_b64_tr_b16 v[208:209], v245 offset:51200
    ds_read_b64_tr_b16 v[210:211], v245 offset:51456
    s_waitcnt lgkmcnt(10)
    v_mfma_f32_32x32x16_bf16 v[144:159], v[180:183], v[176:179], v[144:159]
    v_mfma_f32_32x32x16_bf16 v[160:175], v[184:187], v[176:179], v[160:175]
    ds_read_b128 v[212:215], v243 offset:49152
    ds_read_b64_tr_b16 v[216:217], v244 offset:55296
    ds_read_b64_tr_b16 v[218:219], v244 offset:55808
    ds_read_b64_tr_b16 v[220:221], v245 offset:52224
    ds_read_b64_tr_b16 v[222:223], v245 offset:52480
    s_waitcnt lgkmcnt(10)
    v_mfma_f32_32x32x16_bf16 v[144:159], v[192:195], v[188:191], v[144:159]
    v_mfma_f32_32x32x16_bf16 v[160:175], v[196:199], v[188:191], v[160:175]
    s_waitcnt lgkmcnt(0)
    s_waitcnt vmcnt(0)
    s_barrier
    ds_read_b128 v[88:91], v3
    ds_read_b128 v[92:95], v3 offset:1024
    s_mov_b64 exec, s[44:45]
    ds_read_b128 v[96:99], v4
    ds_read_b128 v[104:107], v4 offset:512
    s_mov_b64 exec, -1
    v_mfma_f32_32x32x16_bf16 v[160:175], v[208:211], v[200:203], v[160:175]
    v_mfma_f32_32x32x16_bf16 v[144:159], v[204:207], v[200:203], v[144:159]
    v_mfma_f32_32x32x16_bf16 v[160:175], v[220:223], v[212:215], v[160:175]
    v_mfma_f32_32x32x16_bf16 v[144:159], v[216:219], v[212:215], v[144:159]
    s_branch L_p1done
L_rare0:
L_rare_1:
    v_lshrrev_b32 v12, 2, v1
    v_and_b32 v13, 3, v1
    v_lshlrev_b32 v12, 7, v12
    v_lshl_add_u32 v12, v13, 4, v12
    s_mov_b32 s50, 4341760
    buffer_load_dwordx4 v[176:179], v12, s[24:27], s50 offen sc1
    buffer_load_dwordx4 v[180:183], v12, s[24:27], s50 offen offset:2048 sc1
    s_mov_b32 s50, 4345856
    buffer_load_dwordx4 v[184:187], v12, s[24:27], s50 offen sc1
    s_mov_b64 s[28:29], s[72:73]
    s_mov_b32 s30, 256
    s_mov_b32 s31, 0x00020000
    v_mov_b32 v12, 0
    buffer_load_dword v188, v12, s[28:31], 0 offen sc1
    s_branch L_back_2
L_rare_3:
    s_waitcnt vmcnt(10)
    v_readfirstlane_b32 s50, v188
    s_nop 3
    s_cmp_lg_u32 s50, 0
    s_cbranch_scc1 L_nd_5
    v_readfirstlane_b32 s50, v176
L_nl_6:
    s_add_u32 s50, s50, 1
    s_cbranch_scc1 L_nl_6
    s_mov_b64 s[84:85], 0
    v_cmp_eq_u32 vcc, s50, v176
    s_or_b64 s[84:85], s[84:85], vcc
    v_cmp_eq_u32 vcc, s50, v177
    s_or_b64 s[84:85], s[84:85], vcc
    v_cmp_eq_u32 vcc, s50, v178
    s_or_b64 s[84:85], s[84:85], vcc
    v_cmp_eq_u32 vcc, s50, v179
    s_or_b64 s[84:85], s[84:85], vcc
    v_cmp_eq_u32 vcc, s50, v180
    s_or_b64 s[84:85], s[84:85], vcc
    v_cmp_eq_u32 vcc, s50, v181
    s_or_b64 s[84:85], s[84:85], vcc
    v_cmp_eq_u32 vcc, s50, v182
    s_or_b64 s[84:85], s[84:85], vcc
    v_cmp_eq_u32 vcc, s50, v183
    s_or_b64 s[84:85], s[84:85], vcc
    v_cmp_eq_u32 vcc, s50, v184
    s_or_b64 s[84:85], s[84:85], vcc
    v_cmp_eq_u32 vcc, s50, v185
    s_or_b64 s[84:85], s[84:85], vcc
    v_cmp_eq_u32 vcc, s50, v186
    s_or_b64 s[84:85], s[84:85], vcc
    v_cmp_eq_u32 vcc, s50, v187
    s_or_b64 s[84:85], s[84:85], vcc
    s_cbranch_scc1 L_nl_6
    v_mov_b32 v192, s50
    v_mov_b32 v193, 0
    s_mov_b64 exec, 1
    buffer_store_dword v192, v193, s[28:31], 0 offen sc1
    s_mov_b64 exec, -1
L_nd_5:
    s_branch L_back_4
L_rare_9:
    v_add_u32 v12, 147456, v6
    v_lshlrev_b32 v13, 2, v1
    v_add_u32 v13, 155648, v13
    ds_read_b128 v[16:19], v12 offset:0
    ds_read_b128 v[20:23], v12 offset:1024
    ds_read_b128 v[24:27], v12 offset:2048
    ds_read_b128 v[28:31], v12 offset:3072
    ds_read_b128 v[32:35], v12 offset:4096
    ds_read_b128 v[36:39], v12 offset:5120
    ds_read_b128 v[40:43], v12 offset:6144
    ds_read_b128 v[44:47], v12 offset:7168
    s_waitcnt lgkmcnt(0)
    ds_read_b32 v64, v13 offset:0
    ds_read_b32 v65, v13 offset:256
    ds_read_b32 v66, v13 offset:512
    ds_read_b32 v67, v13 offset:768
    ds_read_b32 v68, v13 offset:1024
    ds_read_b32 v69, v13 offset:1280
    ds_read_b32 v70, v13 offset:1536
    ds_read_b32 v71, v13 offset:1792
    s_lshr_b32 s49, s4, 1
    s_lshl_b32 s50, s5, 2
    s_lshr_b32 s51, s49, 1
    s_add_u32 s50, s50, s51
    s_lshr_b32 s51, s50, 3
    s_lshl_b32 s51, s51, 14
    s_and_b32 s50, s50, 7
    s_lshl_b32 s50, s50, 10
    s_add_u32 s50, s50, s51
    s_add_u32 s50, s50, 4194304
    s_and_b32 s49, s49, 1
    v_and_b32 v8, 15, v1
    v_bfe_u32 v9, v1, 4, 1
    v_lshrrev_b32 v10, 5, v1
    v_lshlrev_b32 v10, 3, v10
    v_add_f32 v16, v16, v20
    v_add_f32 v17, v17, v21
    v_add_f32 v18, v18, v22
    v_add_f32 v19, v19, v23
    v_add_f32 v16, v16, v24
    v_add_f32 v17, v17, v25
    v_add_f32 v18, v18, v26
    v_add_f32 v19, v19, v27
    v_add_f32 v16, v16, v28
    v_add_f32 v17, v17, v29
    v_add_f32 v18, v18, v30
    v_add_f32 v19, v19, v31
    v_add_f32 v16, v16, v32
    v_add_f32 v17, v17, v33
    v_add_f32 v18, v18, v34
    v_add_f32 v19, v19, v35
    v_add_f32 v16, v16, v36
    v_add_f32 v17, v17, v37
    v_add_f32 v18, v18, v38
    v_add_f32 v19, v19, v39
    v_add_f32 v16, v16, v40
    v_add_f32 v17, v17, v41
    v_add_f32 v18, v18, v42
    v_add_f32 v19, v19, v43
    v_add_f32 v16, v16, v44
    v_add_f32 v17, v17, v45
    v_add_f32 v18, v18, v46
    v_add_f32 v19, v19, v47
    v_cvt_pk_bf16_f32 v16, v16, v17
    v_cvt_pk_bf16_f32 v17, v18, v19
    s_bitcmp1_b32 s4, 0
    s_cbranch_scc1 L_rv_11
    v_and_b32 v11, 3, v8
    v_bfe_u32 v14, v8, 2, 1
    v_lshl_add_u32 v11, v14, 3, v11
    v_bfe_u32 v14, v8, 3, 1
    v_lshl_add_u32 v11, v14, 2, v11
    v_lshl_add_u32 v11, v9, 5, v11
    v_lshl_add_u32 v11, v11, 4, v10
    s_lshl_b32 s49, s49, 8
    s_add_u32 s50, s50, s49
    buffer_store_dwordx2 v[16:17], v11, s[24:27], s50 offen sc1
    s_waitcnt lgkmcnt(0)
    v_add_f32 v64, v64, v65
    v_add_f32 v64, v64, v66
    v_add_f32 v64, v64, v67
    v_add_f32 v64, v64, v68
    v_add_f32 v64, v64, v69
    v_add_f32 v64, v64, v70
    v_add_f32 v64, v64, v71
    v_mul_f32 v64, 0xbfb8aa3b, v64
    v_exp_f32 v64, v64
    s_lshr_b32 s49, s4, 1
    s_lshl_b32 s49, s49, 6
    v_add_f32 v64, 1.0, v64
    v_rcp_f32 v64, v64
    s_lshl_b32 s50, s5, 9
    s_add_u32 s50, s50, s49
    s_add_u32 s50, s50, 4325376
    v_lshlrev_b32 v11, 2, v1
    s_mov_b64 exec, 0xffff
    buffer_store_dword v64, v11, s[24:27], s50 offen sc1
    s_mov_b64 exec, -1
    s_branch L_re_12
L_rv_11:
    v_lshl_add_u32 v11, v9, 4, v8
    v_lshl_add_u32 v11, v11, 4, v10
    s_lshl_b32 s49, s49, 9
    s_add_u32 s50, s50, s49
    s_add_u32 s50, s50, 8192
    buffer_store_dwordx2 v[16:17], v11, s[24:27], s50 offen sc1
    s_waitcnt lgkmcnt(0)
L_re_12:
    s_branch L_back_10
L_rare_15:
    v_mov_b32 v11, 0
    buffer_load_dword v251, v11, s[28:31], 0 offen sc1
    s_branch L_back_16
L_rare_21:
L_gn_23:
    v_readfirstlane_b32 s47, v251
    s_nop 3
    s_cmp_lg_u32 s47, 0
    s_cbranch_scc1 L_gk_24
    s_sub_u32 s48, s48, 1
    s_cbranch_scc1 L_abort
    v_mov_b32 v11, 0
    buffer_load_dword v251, v11, s[28:31], 0 offen sc1
    s_waitcnt vmcnt(0)
    s_branch L_gn_23
L_gk_24:
    s_lshl_b32 s50, s5, 7
    s_lshl_b32 s51, s4, 2
    s_add_u32 s50, s50, s51
    s_add_u32 s50, s50, 4341760
    v_mov_b32 v8, s47
    v_mov_b32 v9, 0
    s_mov_b64 exec, 1
    buffer_store_dword v8, v9, s[24:27], s50 offen sc1
    s_mov_b64 exec, -1
    s_branch L_back_22
L_rare_25:
    v_lshrrev_b32 v8, 2, v1
    v_and_b32 v9, 3, v1
    v_lshlrev_b32 v8, 7, v8
    v_lshl_add_u32 v250, v9, 4, v8
    s_mov_b32 s92, 4341760
    buffer_load_dwordx4 v[252:255], v250, s[24:27], s92 offen sc1
    s_branch L_back_26
L_rare_27:
L_pl_29:
    v_xor_b32 v252, s47, v252
    v_xor_b32 v253, s47, v253
    v_xor_b32 v254, s47, v254
    v_xor_b32 v255, s47, v255
    v_or_b32 v252, v252, v253
    v_or3_b32 v252, v252, v254, v255
    v_cmp_ne_u32 vcc, 0, v252
    s_nop 4
    s_cbranch_vccz L_pk_30
    s_sub_u32 s48, s48, 1
    s_cbranch_scc1 L_abort
    buffer_load_dwordx4 v[252:255], v250, s[24:27], s92 offen sc1
    s_waitcnt vmcnt(0)
    s_branch L_pl_29
L_pk_30:
    s_branch L_back_28
L_rare_33:
    v_mov_b32 v11, 0
    buffer_load_dword v251, v11, s[28:31], 0 offen sc1
    s_branch L_back_34
L_rare_39:
L_gn_41:
    v_readfirstlane_b32 s47, v251
    s_nop 3
    s_cmp_lg_u32 s47, 0
    s_cbranch_scc1 L_gk_42
    s_sub_u32 s48, s48, 1
    s_cbranch_scc1 L_abort
    v_mov_b32 v11, 0
    buffer_load_dword v251, v11, s[28:31], 0 offen sc1
    s_waitcnt vmcnt(0)
    s_branch L_gn_41
L_gk_42:
    s_lshl_b32 s50, s5, 7
    s_lshl_b32 s51, s4, 2
    s_add_u32 s50, s50, s51
    s_add_u32 s50, s50, 4341760
    v_mov_b32 v8, s47
    v_mov_b32 v9, 0
    s_mov_b64 exec, 1
    buffer_store_dword v8, v9, s[24:27], s50 offen sc1
    s_mov_b64 exec, -1
    s_branch L_back_40
L_rare_43:
    v_lshrrev_b32 v8, 2, v1
    v_and_b32 v9, 3, v1
    v_lshlrev_b32 v8, 7, v8
    v_lshl_add_u32 v250, v9, 4, v8
    s_mov_b32 s92, 4341760
    buffer_load_dwordx4 v[252:255], v250, s[24:27], s92 offen sc1
    s_branch L_back_44
L_rare_45:
L_pl_47:
    v_xor_b32 v252, s47, v252
    v_xor_b32 v253, s47, v253
    v_xor_b32 v254, s47, v254
    v_xor_b32 v255, s47, v255
    v_or_b32 v252, v252, v253
    v_or3_b32 v252, v252, v254, v255
    v_cmp_ne_u32 vcc, 0, v252
    s_nop 4
    s_cbranch_vccz L_pk_48
    s_sub_u32 s48, s48, 1
    s_cbranch_scc1 L_abort
    buffer_load_dwordx4 v[252:255], v250, s[24:27], s92 offen sc1
    s_waitcnt vmcnt(0)
    s_branch L_pl_47
L_pk_48:
    s_branch L_back_46
L_p1b:
    s_cmp_eq_u32 s3, 0
    s_cbranch_scc1 L_wa_31
    s_waitcnt vmcnt(4)
L_wa_31:
    s_waitcnt vmcnt(5)
    s_waitcnt lgkmcnt(0)
    s_barrier
    s_cmp_eq_u32 s3, 0
    s_cbranch_scc1 L_rare_33
L_back_34:
    ds_read_b128 v[176:179], v240 offset:0
    ds_read_b64_tr_b16 v[180:181], v244 offset:0
    ds_read_b64_tr_b16 v[182:183], v244 offset:512
    ds_read_b64_tr_b16 v[184:185], v245 offset:0
    ds_read_b64_tr_b16 v[186:187], v245 offset:256
    ds_read_b128 v[188:191], v241 offset:0
    ds_read_b64_tr_b16 v[192:193], v244 offset:2048
    ds_read_b64_tr_b16 v[194:195], v244 offset:2560
    ds_read_b64_tr_b16 v[196:197], v245 offset:1024
    ds_read_b64_tr_b16 v[198:199], v245 offset:1280
    s_add_u32 m0, s80, 32768
    s_add_u32 s93, s76, s82
    buffer_load_dwordx4 v246, s[8:11], s93 offen lds
    s_add_u32 m0, s80, 33792
    s_add_u32 s91, s77, s83
    buffer_load_dwordx4 v247, s[8:11], s93 offen lds
    s_add_u32 m0, s81, 32768
    s_add_u32 s93, s91, s79
    buffer_load_dwordx4 v248, s[12:15], s91 offen lds
    ds_read_b128 v[200:203], v242 offset:0
    ds_read_b64_tr_b16 v[204:205], v244 offset:4096
    ds_read_b64_tr_b16 v[206:207], v244 offset:4608
    ds_read_b64_tr_b16 v[208:209], v245 offset:2048
    ds_read_b64_tr_b16 v[210:211], v245 offset:2304
    s_waitcnt lgkmcnt(10)
    v_mfma_f32_32x32x16_bf16 v[144:159], v[176:179], v[180:183], 0
    v_mfma_f32_32x32x16_bf16 v[160:175], v[184:187], v[176:179], 0
    s_add_u32 m0, s81, 33792
    s_add_u32 s83, s83, s78
    buffer_load_dwordx4 v248, s[12:15], s93 offen lds
    s_add_u32 s82, s82, 128
    s_and_b32 s82, s82, 1023
    s_cselect_b32 s83, s83, 0
    ds_read_b128 v[212:215], v243 offset:0
    ds_read_b64_tr_b16 v[216:217], v244 offset:6144
    ds_read_b64_tr_b16 v[218:219], v244 offset:6656
    ds_read_b64_tr_b16 v[220:221], v245 offset:3072
    ds_read_b64_tr_b16 v[222:223], v245 offset:3328
    s_waitcnt lgkmcnt(10)
    v_mfma_f32_32x32x16_bf16 v[144:159], v[188:191], v[192:195], v[144:159]
    v_mfma_f32_32x32x16_bf16 v[160:175], v[196:199], v[188:191], v[160:175]
    s_waitcnt lgkmcnt(5)
    v_mfma_f32_32x32x16_bf16 v[144:159], v[200:203], v[204:207], v[144:159]
    v_mfma_f32_32x32x16_bf16 v[160:175], v[208:211], v[200:203], v[160:175]
    v_mov_b32 v2, 0xdddddddd
    v_lshrrev_b32 v8, 5, v1
    v_and_b32 v9, 15, v1
    v_lshl_add_u32 v8, v8, 4, v9
    v_lshlrev_b32 v7, 4, v8
    v_and_b32 v8, 31, v1
    v_cmp_eq_u32 vcc, 16, v8
    v_mov_b32 v9, 0x3f803f80
    v_add_u32 v3, 131072, v6
    v_cndmask_b32 v9, 0, v9, vcc
    v_add_u32 v4, 139264, v7
    v_mov_b32 v96, v9
    v_mov_b32 v97, v9
    v_mov_b32 v98, v9
    v_mov_b32 v99, v9
    v_mov_b32 v100, v9
    v_mov_b32 v101, v9
    v_mov_b32 v102, v9
    v_mov_b32 v103, v9
    v_mov_b32 v104, v9
    v_mov_b32 v105, v9
    v_mov_b32 v106, v9
    v_mov_b32 v107, v9
    v_mov_b32 v108, v9
    v_mov_b32 v109, v9
    v_mov_b32 v110, v9
    v_mov_b32 v111, v9
    v_mov_b64 v[112:113], 0
    v_mov_b64 v[114:115], 0
    v_mov_b64 v[116:117], 0
    v_mov_b64 v[118:119], 0
    v_mov_b64 v[120:121], 0
    v_mov_b64 v[122:123], 0
    v_mov_b64 v[124:125], 0
    v_mov_b64 v[126:127], 0
    v_mov_b64 v[48:49], 0
    v_mov_b64 v[50:51], 0
    v_mov_b64 v[52:53], 0
    v_mov_b64 v[54:55], 0
    v_mov_b64 v[56:57], 0
    v_mov_b64 v[58:59], 0
    v_mov_b64 v[60:61], 0
    v_mov_b64 v[62:63], 0
    s_lshl1_add_u32 s50, s4, s99
    s_lshl_b32 s89, s50, 17
    s_lshl_b32 s51, s6, 12
    s_add_u32 s89, s89, s51
    s_lshl1_add_u32 s50, s4, s7
    s_lshl_b32 s51, s5, 2
    s_add_u32 s51, s51, s46
    s_lshl_b32 s51, s51, 5
    s_add_u32 s51, s51, s50
    s_lshl_b32 s90, s51, 10
    s_and_b32 s50, s4, 14
    s_add_u32 s50, s50, s7
    s_lshl_b32 s50, s50, 18
    s_lshr_b32 s51, s5, 1
    s_lshl_b32 s51, s51, 14
    s_add_u32 s50, s50, s51
    s_and_b32 s51, s5, 1
    s_lshl_b32 s51, s51, 2
    s_add_u32 s51, s51, s46
    s_lshl_b32 s51, s51, 10
    s_add_u32 s87, s50, s51
    s_mov_b32 s100, 0x3eb8aa3b
    s_mov_b32 s101, 0x3eb8aa3b
    s_bitcmp1_b32 s4, 0
    s_cbranch_scc1 L_ka_35
    v_and_b32 v8, 0x33, v1
    v_bfe_u32 v9, v1, 2, 1
    v_lshl_or_b32 v8, v9, 3, v8
    v_bfe_u32 v9, v1, 3, 1
    v_lshl_or_b32 v8, v9, 2, v8
    v_lshlrev_b32 v249, 4, v8
    s_add_u32 s98, s87, 131072
    s_branch L_kb_36
L_ka_35:
    v_bfe_u32 v8, v1, 4, 1
    v_lshlrev_b32 v8, 17, v8
    v_lshrrev_b32 v9, 5, v1
    v_and_b32 v10, 15, v1
    v_lshl_add_u32 v9, v9, 4, v10
    v_lshl_add_u32 v249, v9, 4, v8
    s_add_u32 s87, s87, 8192
    s_add_u32 s98, s87, 512
L_kb_36:
    s_cmp_eq_u32 s3, 0
    s_cbranch_scc1 L_wa_37
    s_waitcnt vmcnt(4)
L_wa_37:
    s_waitcnt vmcnt(6)
    s_waitcnt lgkmcnt(0)
    s_barrier
    ds_read_b128 v[176:179], v240 offset:16384
    ds_read_b64_tr_b16 v[180:181], v244 offset:16384
    ds_read_b64_tr_b16 v[182:183], v244 offset:16896
    ds_read_b64_tr_b16 v[184:185], v245 offset:16384
    ds_read_b64_tr_b16 v[186:187], v245 offset:16640
    ds_read_b128 v[188:191], v241 offset:16384
    ds_read_b64_tr_b16 v[192:193], v244 offset:18432
    ds_read_b64_tr_b16 v[194:195], v244 offset:18944
    ds_read_b64_tr_b16 v[196:197], v245 offset:17408
    ds_read_b64_tr_b16 v[198:199], v245 offset:17664
    s_add_u32 m0, s80, 49152
    s_add_u32 s93, s76, s82
    buffer_load_dwordx4 v246, s[8:11], s93 offen lds
    v_mfma_f32_32x32x16_bf16 v[144:159], v[212:215], v[216:219], v[144:159]
    v_mfma_f32_32x32x16_bf16 v[160:175], v[220:223], v[212:215], v[160:175]
    s_add_u32 m0, s80, 50176
    s_add_u32 s91, s77, s83
    buffer_load_dwordx4 v247, s[8:11], s93 offen lds
    s_add_u32 m0, s81, 49152
    s_add_u32 s93, s91, s79
    buffer_load_dwordx4 v248, s[12:15], s91 offen lds
    ds_read_b128 v[200:203], v242 offset:16384
    ds_read_b64_tr_b16 v[204:205], v244 offset:20480
    ds_read_b64_tr_b16 v[206:207], v244 offset:20992
    ds_read_b64_tr_b16 v[208:209], v245 offset:18432
    ds_read_b64_tr_b16 v[210:211], v245 offset:18688
    s_waitcnt lgkmcnt(10)
    v_mfma_f32_32x32x16_bf16 v[144:159], v[176:179], v[180:183], v[144:159]
    v_mfma_f32_32x32x16_bf16 v[160:175], v[184:187], v[176:179], v[160:175]
    s_add_u32 m0, s81, 50176
    s_add_u32 s83, s83, s78
    buffer_load_dwordx4 v248, s[12:15], s93 offen lds
    s_add_u32 s82, s82, 128
    s_and_b32 s82, s82, 1023
    s_cselect_b32 s83, s83, 0
    ds_read_b128 v[212:215], v243 offset:16384
    ds_read_b64_tr_b16 v[216:217], v244 offset:22528
    ds_read_b64_tr_b16 v[218:219], v244 offset:23040
    ds_read_b64_tr_b16 v[220:221], v245 offset:19456
    ds_read_b64_tr_b16 v[222:223], v245 offset:19712
    s_waitcnt lgkmcnt(10)
    v_mfma_f32_32x32x16_bf16 v[144:159], v[188:191], v[192:195], v[144:159]
    v_mfma_f32_32x32x16_bf16 v[160:175], v[196:199], v[188:191], v[160:175]
    s_waitcnt lgkmcnt(5)
    v_mfma_f32_32x32x16_bf16 v[144:159], v[200:203], v[204:207], v[144:159]
    v_mfma_f32_32x32x16_bf16 v[160:175], v[208:211], v[200:203], v[160:175]
    s_mov_b64 s[32:33], s[70:71]
    s_mov_b32 s34, 2097152
    s_mov_b32 s35, 0x00020000
    s_mov_b64 s[36:37], s[56:57]
    s_mov_b32 s38, 524288
    s_mov_b32 s39, 0x00020000
    s_mov_b64 s[40:41], s[66:67]
    s_mov_b32 s42, 524288
    s_mov_b32 s43, 0x00020000
    v_lshrrev_b32 v8, 3, v1
    v_bfe_u32 v9, v1, 2, 1
    v_bfe_u32 v10, v1, 4, 1
    v_xor_b32 v9, v9, v10
    v_lshlrev_b32 v9, 6, v9
    v_lshl_add_u32 v9, v8, 10, v9
    v_and_b32 v11, 3, v1
    v_lshl_add_u32 v224, v11, 4, v9
    v_lshrrev_b32 v8, 5, v1
    v_bfe_u32 v9, v1, 2, 2
    v_lshl_add_u32 v8, v8, 2, v9
    v_lshlrev_b32 v8, 7, v8
    v_bfe_u32 v9, v1, 3, 1
    v_lshl_add_u32 v8, v9, 6, v8
    v_lshl_add_u32 v8, v10, 5, v8
    v_lshl_add_u32 v8, v11, 3, v8
    s_lshl_b32 s50, s6, 13
    s_add_u32 s50, s50, 32768
    s_lshr_b32 s51, s4, 3
    s_lshl_b32 s51, s51, 15
    s_add_u32 s50, s50, s51
    v_add_u32 v230, s50, v8
    v_xor_b32 v231, 64, v230
    s_lshl_b32 s51, s51, 1
    s_sub_u32 s50, s50, s51
    s_add_u32 s50, s50, 32768
    v_add_u32 v228, s50, v8
    v_xor_b32 v229, 64, v228
    s_waitcnt vmcnt(4)
    s_cmp_eq_u32 s3, 0
    s_cbranch_scc1 L_rare_39
L_back_40:
    s_waitcnt lgkmcnt(0)
    s_barrier
    ds_read_b128 v[176:179], v240 offset:32768
    ds_read_b64_tr_b16 v[180:181], v244 offset:32768
    ds_read_b64_tr_b16 v[182:183], v244 offset:33280
    ds_read_b64_tr_b16 v[184:185], v245 offset:32768
    ds_read_b64_tr_b16 v[186:187], v245 offset:33024
    ds_read_b128 v[188:191], v241 offset:32768
    ds_read_b64_tr_b16 v[192:193], v244 offset:34816
    ds_read_b64_tr_b16 v[194:195], v244 offset:35328
    ds_read_b64_tr_b16 v[196:197], v245 offset:33792
    ds_read_b64_tr_b16 v[198:199], v245 offset:34048
    s_add_u32 m0, s80, 0
    s_add_u32 s93, s76, s82
    buffer_load_dwordx4 v246, s[8:11], s93 offen lds
    v_mfma_f32_32x32x16_bf16 v[144:159], v[212:215], v[216:219], v[144:159]
    v_mfma_f32_32x32x16_bf16 v[160:175], v[220:223], v[212:215], v[160:175]
    s_add_u32 m0, s80, 1024
    s_add_u32 s91, s77, s83
    buffer_load_dwordx4 v247, s[8:11], s93 offen lds
    s_add_u32 m0, s81, 0
    s_add_u32 s93, s91, s79
    buffer_load_dwordx4 v248, s[12:15], s91 offen lds
    ds_read_b128 v[200:203], v242 offset:32768
    ds_read_b64_tr_b16 v[204:205], v244 offset:36864
    ds_read_b64_tr_b16 v[206:207], v244 offset:37376
    ds_read_b64_tr_b16 v[208:209], v245 offset:34816
    ds_read_b64_tr_b16 v[210:211], v245 offset:35072
    s_waitcnt lgkmcnt(10)
    v_mfma_f32_32x32x16_bf16 v[144:159], v[176:179], v[180:183], v[144:159]
    v_mfma_f32_32x32x16_bf16 v[160:175], v[184:187], v[176:179], v[160:175]
    s_add_u32 m0, s81, 1024
    s_add_u32 s83, s83, s78
    buffer_load_dwordx4 v248, s[12:15], s93 offen lds
    s_add_u32 s82, s82, 128
    s_and_b32 s82, s82, 1023
    s_cselect_b32 s83, s83, 0
    ds_read_b128 v[212:215], v243 offset:32768
    ds_read_b64_tr_b16 v[216:217], v244 offset:38912
    ds_read_b64_tr_b16 v[218:219], v244 offset:39424
    ds_read_b64_tr_b16 v[220:221], v245 offset:35840
    ds_read_b64_tr_b16 v[222:223], v245 offset:36096
    s_waitcnt lgkmcnt(10)
    v_mfma_f32_32x32x16_bf16 v[144:159], v[188:191], v[192:195], v[144:159]
    v_mfma_f32_32x32x16_bf16 v[160:175], v[196:199], v[188:191], v[160:175]
    s_waitcnt lgkmcnt(5)
    v_mfma_f32_32x32x16_bf16 v[144:159], v[200:203], v[204:207], v[144:159]
    v_mfma_f32_32x32x16_bf16 v[160:175], v[208:211], v[200:203], v[160:175]
    s_waitcnt vmcnt(4)
    s_waitcnt lgkmcnt(0)
    s_barrier
    ds_read_b128 v[176:179], v240 offset:49152
    ds_read_b64_tr_b16 v[180:181], v244 offset:49152
    ds_read_b64_tr_b16 v[182:183], v244 offset:49664
    ds_read_b64_tr_b16 v[184:185], v245 offset:49152
    ds_read_b64_tr_b16 v[186:187], v245 offset:49408
    ds_read_b128 v[188:191], v241 offset:49152
    ds_read_b64_tr_b16 v[192:193], v244 offset:51200
    ds_read_b64_tr_b16 v[194:195], v244 offset:51712
    ds_read_b64_tr_b16 v[196:197], v245 offset:50176
    ds_read_b64_tr_b16 v[198:199], v245 offset:50432
    s_add_u32 m0, s80, 16384
    s_add_u32 s93, s76, s82
    buffer_load_dwordx4 v246, s[8:11], s93 offen lds
    v_mfma_f32_32x32x16_bf16 v[144:159], v[212:215], v[216:219], v[144:159]
    v_mfma_f32_32x32x16_bf16 v[160:175], v[220:223], v[212:215], v[160:175]
    s_add_u32 m0, s80, 17408
    s_add_u32 s91, s77, s83
    buffer_load_dwordx4 v247, s[8:11], s93 offen lds
    s_add_u32 m0, s81, 16384
    s_add_u32 s93, s91, s79
    buffer_load_dwordx4 v248, s[12:15], s91 offen lds
    ds_read_b128 v[200:203], v242 offset:49152
    ds_read_b64_tr_b16 v[204:205], v244 offset:53248
    ds_read_b64_tr_b16 v[206:207], v244 offset:53760
    ds_read_b64_tr_b16 v[208:209], v245 offset:51200
    ds_read_b64_tr_b16 v[210:211], v245 offset:51456
    s_waitcnt lgkmcnt(10)
    v_mfma_f32_32x32x16_bf16 v[144:159], v[176:179], v[180:183], v[144:159]
    v_mfma_f32_32x32x16_bf16 v[160:175], v[184:187], v[176:179], v[160:175]
    s_add_u32 m0, s81, 17408
    s_add_u32 s83, s83, s78
    buffer_load_dwordx4 v248, s[12:15], s93 offen lds
    s_add_u32 s82, s82, 128
    s_and_b32 s82, s82, 1023
    s_cselect_b32 s83, s83, 0
    ds_read_b128 v[212:215], v243 offset:49152
    ds_read_b64_tr_b16 v[216:217], v244 offset:55296
    ds_read_b64_tr_b16 v[218:219], v244 offset:55808
    ds_read_b64_tr_b16 v[220:221], v245 offset:52224
    ds_read_b64_tr_b16 v[222:223], v245 offset:52480
    s_waitcnt lgkmcnt(10)
    v_mfma_f32_32x32x16_bf16 v[144:159], v[188:191], v[192:195], v[144:159]
    v_mfma_f32_32x32x16_bf16 v[160:175], v[196:199], v[188:191], v[160:175]
    s_waitcnt lgkmcnt(5)
    v_mfma_f32_32x32x16_bf16 v[144:159], v[200:203], v[204:207], v[144:159]
    v_mfma_f32_32x32x16_bf16 v[160:175], v[208:211], v[200:203], v[160:175]
    s_waitcnt vmcnt(4)
    s_waitcnt lgkmcnt(0)
    s_barrier
    ds_read_b128 v[176:179], v240 offset:0
    ds_read_b64_tr_b16 v[180:181], v244 offset:0
    ds_read_b64_tr_b16 v[182:183], v244 offset:512
    ds_read_b64_tr_b16 v[184:185], v245 offset:0
    ds_read_b64_tr_b16 v[186:187], v245 offset:256
    ds_read_b128 v[188:191], v241 offset:0
    ds_read_b64_tr_b16 v[192:193], v244 offset:2048
    ds_read_b64_tr_b16 v[194:195], v244 offset:2560
    ds_read_b64_tr_b16 v[196:197], v245 offset:1024
    ds_read_b64_tr_b16 v[198:199], v245 offset:1280
    s_add_u32 m0, s80, 32768
    s_add_u32 s93, s76, s82
    buffer_load_dwordx4 v246, s[8:11], s93 offen lds
    v_mfma_f32_32x32x16_bf16 v[144:159], v[212:215], v[216:219], v[144:159]
    v_mfma_f32_32x32x16_bf16 v[160:175], v[220:223], v[212:215], v[160:175]
    s_add_u32 m0, s80, 33792
    s_add_u32 s91, s77, s83
    buffer_load_dwordx4 v247, s[8:11], s93 offen lds
    s_add_u32 m0, s81, 32768
    s_add_u32 s93, s91, s79
    buffer_load_dwordx4 v248, s[12:15], s91 offen lds
    ds_read_b128 v[200:203], v242 offset:0
    ds_read_b64_tr_b16 v[204:205], v244 offset:4096
    ds_read_b64_tr_b16 v[206:207], v244 offset:4608
    ds_read_b64_tr_b16 v[208:209], v245 offset:2048
    ds_read_b64_tr_b16 v[210:211], v245 offset:2304
    s_waitcnt lgkmcnt(10)
    v_mfma_f32_32x32x16_bf16 v[144:159], v[176:179], v[180:183], v[144:159]
    v_mfma_f32_32x32x16_bf16 v[160:175], v[184:187], v[176:179], v[160:175]
    s_add_u32 m0, s81, 33792
    s_add_u32 s83, s83, s78
    buffer_load_dwordx4 v248, s[12:15], s93 offen lds
    s_add_u32 s82, s82, 128
    s_and_b32 s82, s82, 1023
    s_cselect_b32 s83, s83, 0
    ds_read_b128 v[212:215], v243 offset:0
    ds_read_b64_tr_b16 v[216:217], v244 offset:6144
    ds_read_b64_tr_b16 v[218:219], v244 offset:6656
    ds_read_b64_tr_b16 v[220:221], v245 offset:3072
    ds_read_b64_tr_b16 v[222:223], v245 offset:3328
    s_waitcnt lgkmcnt(10)
    v_mfma_f32_32x32x16_bf16 v[144:159], v[188:191], v[192:195], v[144:159]
    v_mfma_f32_32x32x16_bf16 v[160:175], v[196:199], v[188:191], v[160:175]
    s_waitcnt lgkmcnt(5)
    v_mfma_f32_32x32x16_bf16 v[144:159], v[200:203], v[204:207], v[144:159]
    v_mfma_f32_32x32x16_bf16 v[160:175], v[208:211], v[200:203], v[160:175]
    s_waitcnt vmcnt(4)
    s_waitcnt lgkmcnt(0)
    s_barrier
    s_cmp_eq_u32 s3, 0
    s_cbranch_scc1 L_rare_43
L_back_44:
    ds_read_b128 v[176:179], v240 offset:16384
    ds_read_b64_tr_b16 v[180:181], v244 offset:16384
    ds_read_b64_tr_b16 v[182:183], v244 offset:16896
    ds_read_b64_tr_b16 v[184:185], v245 offset:16384
    ds_read_b64_tr_b16 v[186:187], v245 offset:16640
    ds_read_b128 v[188:191], v241 offset:16384
    ds_read_b64_tr_b16 v[192:193], v244 offset:18432
    ds_read_b64_tr_b16 v[194:195], v244 offset:18944
    ds_read_b64_tr_b16 v[196:197], v245 offset:17408
    ds_read_b64_tr_b16 v[198:199], v245 offset:17664
    s_add_u32 m0, s80, 49152
    s_add_u32 s93, s76, s82
    buffer_load_dwordx4 v246, s[8:11], s93 offen lds
    v_mfma_f32_32x32x16_bf16 v[144:159], v[212:215], v[216:219], v[144:159]
    v_mfma_f32_32x32x16_bf16 v[160:175], v[220:223], v[212:215], v[160:175]
    s_add_u32 m0, s80, 50176
    s_add_u32 s91, s77, s83
    buffer_load_dwordx4 v247, s[8:11], s93 offen lds
    s_add_u32 m0, s81, 49152
    s_add_u32 s93, s91, s79
    buffer_load_dwordx4 v248, s[12:15], s91 offen lds
    ds_read_b128 v[200:203], v242 offset:16384
    ds_read_b64_tr_b16 v[204:205], v244 offset:20480
    ds_read_b64_tr_b16 v[206:207], v244 offset:20992
    ds_read_b64_tr_b16 v[208:209], v245 offset:18432
    ds_read_b64_tr_b16 v[210:211], v245 offset:18688
    s_waitcnt lgkmcnt(10)
    v_mfma_f32_32x32x16_bf16 v[144:159], v[176:179], v[180:183], v[144:159]
    v_mfma_f32_32x32x16_bf16 v[160:175], v[184:187], v[176:179], v[160:175]
    s_add_u32 m0, s81, 50176
    s_add_u32 s83, s83, s78
    buffer_load_dwordx4 v248, s[12:15], s93 offen lds
    ds_read_b128 v[212:215], v243 offset:16384
    ds_read_b64_tr_b16 v[216:217], v244 offset:22528
    ds_read_b64_tr_b16 v[218:219], v244 offset:23040
    ds_read_b64_tr_b16 v[220:221], v245 offset:19456
    ds_read_b64_tr_b16 v[222:223], v245 offset:19712
    s_waitcnt lgkmcnt(10)
    v_mfma_f32_32x32x16_bf16 v[144:159], v[188:191], v[192:195], v[144:159]
    v_mfma_f32_32x32x16_bf16 v[160:175], v[196:199], v[188:191], v[160:175]
    s_waitcnt lgkmcnt(5)
    v_mfma_f32_32x32x16_bf16 v[144:159], v[200:203], v[204:207], v[144:159]
    v_mfma_f32_32x32x16_bf16 v[160:175], v[208:211], v[200:203], v[160:175]
    s_waitcnt vmcnt(4)
    s_cmp_eq_u32 s3, 0
    s_cbranch_scc1 L_rare_45
L_back_46:
    s_waitcnt lgkmcnt(0)
    s_barrier
    ds_read_b128 v[176:179], v240 offset:32768
    ds_read_b64_tr_b16 v[180:181], v244 offset:32768
    ds_read_b64_tr_b16 v[182:183], v244 offset:33280
    ds_read_b64_tr_b16 v[184:185], v245 offset:32768
    ds_read_b64_tr_b16 v[186:187], v245 offset:33024
    ds_read_b128 v[188:191], v241 offset:32768
    ds_read_b64_tr_b16 v[192:193], v244 offset:34816
    ds_read_b64_tr_b16 v[194:195], v244 offset:35328
    ds_read_b64_tr_b16 v[196:197], v245 offset:33792
    ds_read_b64_tr_b16 v[198:199], v245 offset:34048
    s_lshl_b32 s51, s3, 12
    s_add_u32 m0, s51, 131072
    s_add_u32 s93, s51, 4194304
    buffer_load_dwordx4 v6, s[24:27], s93 offen offset:0 sc1 lds
    v_mfma_f32_32x32x16_bf16 v[144:159], v[212:215], v[216:219], v[144:159]
    v_mfma_f32_32x32x16_bf16 v[160:175], v[220:223], v[212:215], v[160:175]
    buffer_load_dwordx4 v6, s[24:27], s93 offen offset:1024 sc1 lds
    buffer_load_dwordx4 v6, s[24:27], s93 offen offset:2048 sc1 lds
    ds_read_b128 v[200:203], v242 offset:32768
    ds_read_b64_tr_b16 v[204:205], v244 offset:36864
    ds_read_b64_tr_b16 v[206:207], v244 offset:37376
    ds_read_b64_tr_b16 v[208:209], v245 offset:34816
    ds_read_b64_tr_b16 v[210:211], v245 offset:35072
    s_waitcnt lgkmcnt(10)
    v_mfma_f32_32x32x16_bf16 v[144:159], v[176:179], v[180:183], v[144:159]
    v_mfma_f32_32x32x16_bf16 v[160:175], v[184:187], v[176:179], v[160:175]
    buffer_load_dwordx4 v6, s[24:27], s93 offen offset:3072 sc1 lds
    ds_read_b128 v[212:215], v243 offset:32768
    ds_read_b64_tr_b16 v[216:217], v244 offset:38912
    ds_read_b64_tr_b16 v[218:219], v244 offset:39424
    ds_read_b64_tr_b16 v[220:221], v245 offset:35840
    ds_read_b64_tr_b16 v[222:223], v245 offset:36096
    s_waitcnt lgkmcnt(10)
    v_mfma_f32_32x32x16_bf16 v[144:159], v[188:191], v[192:195], v[144:159]
    v_mfma_f32_32x32x16_bf16 v[160:175], v[196:199], v[188:191], v[160:175]
    s_waitcnt lgkmcnt(5)
    v_mfma_f32_32x32x16_bf16 v[144:159], v[200:203], v[204:207], v[144:159]
    v_mfma_f32_32x32x16_bf16 v[160:175], v[208:211], v[200:203], v[160:175]
    s_waitcnt vmcnt(4)
    s_waitcnt lgkmcnt(0)
    s_barrier
    ds_read_b128 v[176:179], v240 offset:49152
    ds_read_b64_tr_b16 v[180:181], v244 offset:49152
    ds_read_b64_tr_b16 v[182:183], v244 offset:49664
    ds_read_b64_tr_b16 v[184:185], v245 offset:49152
    ds_read_b64_tr_b16 v[186:187], v245 offset:49408
    ds_read_b128 v[188:191], v241 offset:49152
    ds_read_b64_tr_b16 v[192:193], v244 offset:51200
    ds_read_b64_tr_b16 v[194:195], v244 offset:51712
    ds_read_b64_tr_b16 v[196:197], v245 offset:50176
    ds_read_b64_tr_b16 v[198:199], v245 offset:50432
    v_mfma_f32_32x32x16_bf16 v[144:159], v[212:215], v[216:219], v[144:159]
    v_mfma_f32_32x32x16_bf16 v[160:175], v[220:223], v[212:215], v[160:175]
    ds_read_b128 v[200:203], v242 offset:49152
    ds_read_b64_tr_b16 v[204:205], v244 offset:53248
    ds_read_b64_tr_b16 v[206:207], v244 offset:53760
    ds_read_b64_tr_b16 v[208:209], v245 offset:51200
    ds_read_b64_tr_b16 v[210:211], v245 offset:51456
    s_waitcnt lgkmcnt(10)
    v_mfma_f32_32x32x16_bf16 v[144:159], v[176:179], v[180:183], v[144:159]
    v_mfma_f32_32x32x16_bf16 v[160:175], v[184:187], v[176:179], v[160:175]
    ds_read_b128 v[212:215], v243 offset:49152
    ds_read_b64_tr_b16 v[216:217], v244 offset:55296
    ds_read_b64_tr_b16 v[218:219], v244 offset:55808
    ds_read_b64_tr_b16 v[220:221], v245 offset:52224
    ds_read_b64_tr_b16 v[222:223], v245 offset:52480
    s_waitcnt lgkmcnt(10)
    v_mfma_f32_32x32x16_bf16 v[144:159], v[188:191], v[192:195], v[144:159]
    v_mfma_f32_32x32x16_bf16 v[160:175], v[196:199], v[188:191], v[160:175]
    s_waitcnt lgkmcnt(0)
    s_waitcnt vmcnt(0)
    s_barrier
    ds_read_b128 v[88:91], v3
    ds_read_b128 v[92:95], v3 offset:1024
    s_mov_b64 exec, s[44:45]
    ds_read_b128 v[96:99], v4
    ds_read_b128 v[104:107], v4 offset:512
    s_mov_b64 exec, -1
    v_mfma_f32_32x32x16_bf16 v[160:175], v[208:211], v[200:203], v[160:175]
    v_mfma_f32_32x32x16_bf16 v[144:159], v[200:203], v[204:207], v[144:159]
    v_mfma_f32_32x32x16_bf16 v[160:175], v[220:223], v[212:215], v[160:175]
    v_mfma_f32_32x32x16_bf16 v[144:159], v[212:215], v[216:219], v[144:159]
L_p1done:
    v_mov_b64 v[12:13], -1
    v_mov_b64 v[14:15], -1
    s_nop 8
    v_pk_mul_f32 v[168:169], v[168:169], s[100:101]
    v_pk_mul_f32 v[170:171], v[170:171], s[100:101]
    v_pk_mul_f32 v[172:173], v[172:173], s[100:101]
    v_pk_mul_f32 v[174:175], v[174:175], s[100:101]
    v_cvt_pk_bf16_f32 v84, v168, v169
    v_cvt_pk_bf16_f32 v85, v170, v171
    v_cvt_pk_bf16_f32 v86, v172, v173
    v_cvt_pk_bf16_f32 v87, v174, v175
    s_waitcnt lgkmcnt(3)
    s_nop 0
    v_mfma_f32_32x32x16_bf16 v[32:47], v[88:91], v[84:87], 0
    v_cvt_pk_bf16_f32 v176, v144, v145
    v_cvt_pk_bf16_f32 v177, v146, v147
    v_cvt_pk_bf16_f32 v178, v148, v149
    v_cvt_pk_bf16_f32 v179, v150, v151
    v_cvt_pk_bf16_f32 v180, v152, v153
    v_cvt_pk_bf16_f32 v181, v154, v155
    v_cvt_pk_bf16_f32 v182, v156, v157
    v_cvt_pk_bf16_f32 v183, v158, v159
    v_pk_mul_f32 v[160:161], v[160:161], s[100:101]
    v_pk_mul_f32 v[162:163], v[162:163], s[100:101]
    v_pk_mul_f32 v[164:165], v[164:165], s[100:101]
    v_pk_mul_f32 v[166:167], v[166:167], s[100:101]
    v_max3_f32 v8, v32, v33, v34
    v_max3_f32 v9, v35, v36, v37
    v_max3_f32 v8, v8, v38, v39
    v_max3_f32 v9, v9, v40, v41
    v_max3_f32 v8, v8, v42, v43
    v_max3_f32 v9, v9, v44, v45
    v_max3_f32 v8, v8, v46, v47
    v_max_f32 v8, v8, v9
    v_mov_b32 v9, v8
    s_nop 1
    v_permlane32_swap_b32 v8, v9
    s_nop 0
    v_max_f32 v8, v8, v9
    v_sub_f32 v64, 0xc2cc0000, v8
    v_sub_f32 v65, 0xc2cc0000, v8
    v_mov_b64 v[66:67], v[64:65]
    v_mov_b64 v[68:69], v[64:65]
    v_mov_b64 v[70:71], v[64:65]
    v_mov_b64 v[72:73], v[64:65]
    v_mov_b64 v[74:75], v[64:65]
    v_mov_b64 v[76:77], v[64:65]
    v_mov_b64 v[78:79], v[64:65]
    s_nop 1
    v_mfma_f32_32x32x16_bf16 v[16:31], v[88:91], v[84:87], v[64:79]
    v_cvt_pk_bf16_f32 v80, v160, v161
    v_cvt_pk_bf16_f32 v81, v162, v163
    v_cvt_pk_bf16_f32 v82, v164, v165
    v_cvt_pk_bf16_f32 v83, v166, v167
    s_nop 7
    v_exp_f32 v16, v16
    v_exp_f32 v17, v17
    s_mov_b64 exec, s[44:45]
    s_waitcnt lgkmcnt(0)
    ds_read_b128 v[100:103], v4 offset:1024
    ds_read_b128 v[108:111], v4 offset:1536
    s_mov_b64 exec, -1
    ds_read_b128 v[88:91], v3 offset:2048
    v_exp_f32 v18, v18
    v_exp_f32 v19, v19
    v_exp_f32 v20, v20
    v_mfma_f32_32x32x16_bf16 v[32:47], v[92:95], v[84:87], v[64:79]
    v_exp_f32 v21, v21
    s_lshl_b32 s51, s3, 12
    s_add_u32 m0, s51, 0
    s_add_u32 s93, s51, 4227072
    buffer_load_dwordx4 v6, s[24:27], s93 offen offset:0 sc1 lds
    v_exp_f32 v22, v22
    v_exp_f32 v23, v23
    v_exp_f32 v24, v24
    v_exp_f32 v25, v25
    v_smfmac_f32_32x32x32_bf16 v[112:127], v[96:99], v[16:23], v2
    s_setprio 1
    v_exp_f32 v26, v26
    v_exp_f32 v27, v27
    v_exp_f32 v28, v28
    buffer_load_dwordx4 v6, s[24:27], s93 offen offset:1024 sc1 lds
    v_exp_f32 v29, v29
    v_exp_f32 v30, v30
    v_exp_f32 v31, v31
    v_exp_f32 v32, v32
    buffer_load_dwordx4 v6, s[24:27], s93 offen offset:2048 sc1 lds
    v_exp_f32 v33, v33
    v_smfmac_f32_32x32x32_bf16 v[112:127], v[104:107], v[24:31], v2
    s_mov_b64 exec, s[44:45]
    s_waitcnt lgkmcnt(0)
    ds_read_b128 v[96:99], v4 offset:2048
    ds_read_b128 v[104:107], v4 offset:2560
    s_mov_b64 exec, -1
    ds_read_b128 v[92:95], v3 offset:3072
    v_exp_f32 v34, v34
    v_exp_f32 v35, v35
    v_exp_f32 v36, v36
    v_mfma_f32_32x32x16_bf16 v[16:31], v[88:91], v[84:87], v[64:79]
    s_setprio 0
    v_exp_f32 v37, v37
    buffer_load_dwordx4 v6, s[24:27], s93 offen offset:3072 sc1 lds
    v_exp_f32 v38, v38
    v_exp_f32 v39, v39
    v_exp_f32 v40, v40
    v_exp_f32 v41, v41
    v_smfmac_f32_32x32x32_bf16 v[112:127], v[100:103], v[32:39], v2
    s_barrier
    v_exp_f32 v42, v42
    v_exp_f32 v43, v43
    v_exp_f32 v44, v44
    v_exp_f32 v45, v45
    v_exp_f32 v46, v46
    v_exp_f32 v47, v47
    v_exp_f32 v16, v16
    v_exp_f32 v17, v17
    v_smfmac_f32_32x32x32_bf16 v[112:127], v[108:111], v[40:47], v2
    s_mov_b64 exec, s[44:45]
    s_waitcnt lgkmcnt(0)
    ds_read_b128 v[100:103], v4 offset:3072
    ds_read_b128 v[108:111], v4 offset:3584
    s_mov_b64 exec, -1
    ds_read_b128 v[88:91], v3 offset:4096
    v_exp_f32 v18, v18
    v_exp_f32 v19, v19
    v_exp_f32 v20, v20
    v_mfma_f32_32x32x16_bf16 v[32:47], v[92:95], v[84:87], v[64:79]
    s_setprio 3
    v_exp_f32 v21, v21
    v_exp_f32 v22, v22
    v_exp_f32 v23, v23
    v_exp_f32 v24, v24
    v_exp_f32 v25, v25
    v_smfmac_f32_32x32x32_bf16 v[112:127], v[96:99], v[16:23], v2
    s_lshl_b32 s51, s3, 12
    s_add_u32 m0, s51, 32768
    s_add_u32 s93, s51, 4259840
    buffer_load_dwordx4 v6, s[24:27], s93 offen offset:0 sc1 lds
    v_exp_f32 v26, v26
    v_exp_f32 v27, v27
    v_exp_f32 v28, v28
    v_exp_f32 v29, v29
    v_exp_f32 v30, v30
    v_exp_f32 v31, v31
    v_exp_f32 v32, v32
    v_exp_f32 v33, v33
    v_smfmac_f32_32x32x32_bf16 v[112:127], v[104:107], v[24:31], v2
    s_mov_b64 exec, s[44:45]
    s_waitcnt lgkmcnt(0)
    ds_read_b128 v[96:99], v4 offset:4096
    ds_read_b128 v[104:107], v4 offset:4608
    s_mov_b64 exec, -1
    ds_read_b128 v[92:95], v3 offset:5120
    v_exp_f32 v34, v34
    v_exp_f32 v35, v35
    v_exp_f32 v36, v36
    v_mfma_f32_32x32x16_bf16 v[16:31], v[88:91], v[84:87], v[64:79]
    v_exp_f32 v37, v37
    v_exp_f32 v38, v38
    v_exp_f32 v39, v39
    v_exp_f32 v40, v40
    v_mov_b32 v8, v120
    v_mov_b32 v9, v120
    v_exp_f32 v41, v41
    v_smfmac_f32_32x32x32_bf16 v[112:127], v[100:103], v[32:39], v2
    buffer_load_dwordx4 v6, s[24:27], s93 offen offset:1024 sc1 lds
    v_exp_f32 v42, v42
    v_permlane32_swap_b32 v8, v9
    v_exp_f32 v43, v43
    v_frexp_exp_i32_f32 v8, v8
    v_add_u32 v8, 101, v8
    v_min_i32 v8, 0x78, v8
    v_cvt_f32_i32 v9, v8
    v_sub_u32 v8, 0, v8
    v_ldexp_f32 v10, 1.0, v8
    v_exp_f32 v44, v44
    v_sub_f32 v64, v64, v9
    v_sub_f32 v65, v65, v9
    v_mov_b64 v[66:67], v[64:65]
    v_mov_b64 v[68:69], v[64:65]
    v_mov_b64 v[70:71], v[64:65]
    v_mov_b64 v[72:73], v[64:65]
    v_mov_b64 v[74:75], v[64:65]
    v_mov_b64 v[76:77], v[64:65]
    v_mov_b64 v[78:79], v[64:65]
    v_exp_f32 v45, v45
    v_exp_f32 v46, v46
    v_exp_f32 v47, v47
    v_exp_f32 v16, v16
    v_exp_f32 v17, v17
    v_smfmac_f32_32x32x32_bf16 v[112:127], v[108:111], v[40:47], v2
    s_mov_b64 exec, s[44:45]
    s_waitcnt lgkmcnt(0)
    ds_read_b128 v[100:103], v4 offset:5120
    ds_read_b128 v[108:111], v4 offset:5632
    s_mov_b64 exec, -1
    ds_read_b128 v[88:91], v3 offset:6144
    v_exp_f32 v18, v18
    v_exp_f32 v19, v19
    v_exp_f32 v20, v20
    v_mfma_f32_32x32x16_bf16 v[32:47], v[92:95], v[84:87], v[64:79]
    v_exp_f32 v21, v21
    buffer_store_dwordx4 v[176:179], v249, s[24:27], s87 offen sc1
    v_exp_f32 v22, v22
    v_exp_f32 v23, v23
    v_exp_f32 v24, v24
    v_exp_f32 v25, v25
    v_smfmac_f32_32x32x32_bf16 v[112:127], v[96:99], v[16:23], v2
    buffer_load_dwordx4 v6, s[24:27], s93 offen offset:2048 sc1 lds
    v_exp_f32 v26, v26
    v_exp_f32 v27, v27
    v_exp_f32 v28, v28
    v_exp_f32 v29, v29
    v_exp_f32 v30, v30
    v_exp_f32 v31, v31
    v_exp_f32 v32, v32
    v_exp_f32 v33, v33
    v_smfmac_f32_32x32x32_bf16 v[112:127], v[104:107], v[24:31], v2
    s_mov_b64 exec, s[44:45]
    s_waitcnt lgkmcnt(0)
    ds_read_b128 v[96:99], v4 offset:6144
    ds_read_b128 v[104:107], v4 offset:6656
    s_mov_b64 exec, -1
    ds_read_b128 v[92:95], v3 offset:7168
    v_exp_f32 v34, v34
    v_exp_f32 v35, v35
    v_exp_f32 v36, v36
    v_mfma_f32_32x32x16_bf16 v[16:31], v[88:91], v[84:87], v[64:79]
    v_exp_f32 v37, v37
    buffer_store_dwordx4 v[180:183], v249, s[24:27], s98 offen sc1
    v_exp_f32 v38, v38
    v_exp_f32 v39, v39
    v_exp_f32 v40, v40
    v_pk_mul_f32 v[112:113], v[112:113], v[10:11] op_sel_hi:[1,0]
    v_pk_mul_f32 v[114:115], v[114:115], v[10:11] op_sel_hi:[1,0]
    v_pk_mul_f32 v[116:117], v[116:117], v[10:11] op_sel_hi:[1,0]
    v_pk_mul_f32 v[118:119], v[118:119], v[10:11] op_sel_hi:[1,0]
    v_mul_f32 v120, v10, v120
    s_nop 0
    v_exp_f32 v41, v41
    v_smfmac_f32_32x32x32_bf16 v[112:127], v[100:103], v[32:39], v2
    s_setprio 2
    buffer_load_dwordx4 v6, s[24:27], s93 offen offset:3072 sc1 lds
    v_exp_f32 v42, v42
    v_exp_f32 v43, v43
    v_exp_f32 v44, v44
    v_exp_f32 v45, v45
    v_exp_f32 v46, v46
    v_exp_f32 v47, v47
    v_add_u32 v3, 16384, v3
    v_exp_f32 v16, v16
    v_exp_f32 v17, v17
    v_smfmac_f32_32x32x32_bf16 v[112:127], v[108:111], v[40:47], v2
    s_mov_b64 exec, s[44:45]
    s_waitcnt lgkmcnt(0)
    ds_read_b128 v[100:103], v4 offset:7168
    ds_read_b128 v[108:111], v4 offset:7680
    s_mov_b64 exec, -1
    ds_read_b128 v[88:91], v3 offset:0
    v_exp_f32 v18, v18
    v_exp_f32 v19, v19
    v_exp_f32 v20, v20
    v_mfma_f32_32x32x16_bf16 v[32:47], v[92:95], v[84:87], v[64:79]
    v_exp_f32 v21, v21
    s_add_u32 s50, s90, 7340032
    buffer_store_dwordx4 v[12:15], v6, s[24:27], s50 offen sc1
    v_exp_f32 v22, v22
    v_exp_f32 v23, v23
    v_exp_f32 v24, v24
    v_exp_f32 v25, v25
    v_smfmac_f32_32x32x32_bf16 v[112:127], v[96:99], v[16:23], v2
    v_exp_f32 v26, v26
    v_exp_f32 v27, v27
    v_exp_f32 v28, v28
    v_exp_f32 v29, v29
    v_exp_f32 v30, v30
    v_exp_f32 v31, v31
    v_add_u32 v4, 16384, v4
    v_exp_f32 v32, v32
    v_exp_f32 v33, v33
    v_smfmac_f32_32x32x32_bf16 v[112:127], v[104:107], v[24:31], v2
    s_mov_b64 exec, s[44:45]
    s_waitcnt lgkmcnt(0)
    ds_read_b128 v[96:99], v4 offset:0
    ds_read_b128 v[104:107], v4 offset:512
    s_mov_b64 exec, -1
    ds_read_b128 v[92:95], v3 offset:1024
    v_exp_f32 v34, v34
    v_exp_f32 v35, v35
    v_exp_f32 v36, v36
    v_mfma_f32_32x32x16_bf16 v[16:31], v[88:91], v[84:87], v[64:79]
    v_exp_f32 v37, v37
    v_and_b32 v8, 31, v1
    v_lshlrev_b32 v8, 2, v8
    s_lshl_b32 s50, s5, 2
    s_add_u32 s50, s50, s46
    s_lshl_b32 s50, s50, 7
    s_add_u32 s50, s50, 4325376
    buffer_load_dword v5, v8, s[24:27], s50 offen sc1
    v_exp_f32 v38, v38
    v_exp_f32 v39, v39
    v_exp_f32 v40, v40
    v_exp_f32 v41, v41
    v_smfmac_f32_32x32x32_bf16 v[112:127], v[100:103], v[32:39], v2
    v_exp_f32 v42, v42
    v_exp_f32 v43, v43
    v_exp_f32 v44, v44
    v_exp_f32 v45, v45
    v_exp_f32 v46, v46
    v_exp_f32 v47, v47
    v_exp_f32 v16, v16
    v_exp_f32 v17, v17
    v_smfmac_f32_32x32x32_bf16 v[112:127], v[108:111], v[40:47], v2
    s_mov_b64 exec, s[44:45]
    s_waitcnt lgkmcnt(0)
    ds_read_b128 v[100:103], v4 offset:1024
    ds_read_b128 v[108:111], v4 offset:1536
    s_mov_b64 exec, -1
    ds_read_b128 v[88:91], v3 offset:2048
    v_exp_f32 v18, v18
    v_exp_f32 v19, v19
    v_exp_f32 v20, v20
    v_mfma_f32_32x32x16_bf16 v[32:47], v[92:95], v[84:87], v[64:79]
    v_exp_f32 v21, v21
    v_exp_f32 v22, v22
    v_exp_f32 v23, v23
    v_exp_f32 v24, v24
    v_exp_f32 v25, v25
    v_smfmac_f32_32x32x32_bf16 v[112:127], v[96:99], v[16:23], v2
    s_setprio 1
    v_exp_f32 v26, v26
    v_exp_f32 v27, v27
    v_exp_f32 v28, v28
    v_exp_f32 v29, v29
    v_exp_f32 v30, v30
    v_exp_f32 v31, v31
    v_exp_f32 v32, v32
    v_exp_f32 v33, v33
    v_smfmac_f32_32x32x32_bf16 v[112:127], v[104:107], v[24:31], v2
    s_mov_b64 exec, s[44:45]
    s_waitcnt lgkmcnt(0)
    ds_read_b128 v[96:99], v4 offset:2048
    ds_read_b128 v[104:107], v4 offset:2560
    s_mov_b64 exec, -1
    ds_read_b128 v[92:95], v3 offset:3072
    v_exp_f32 v34, v34
    v_exp_f32 v35, v35
    v_exp_f32 v36, v36
    v_mfma_f32_32x32x16_bf16 v[16:31], v[88:91], v[84:87], v[64:79]
    s_setprio 0
    v_exp_f32 v37, v37
    v_exp_f32 v38, v38
    v_exp_f32 v39, v39
    v_exp_f32 v40, v40
    v_exp_f32 v41, v41
    v_smfmac_f32_32x32x32_bf16 v[112:127], v[100:103], v[32:39], v2
    s_waitcnt vmcnt(8)
    s_barrier
    v_exp_f32 v42, v42
    v_exp_f32 v43, v43
    v_exp_f32 v44, v44
    v_exp_f32 v45, v45
    v_exp_f32 v46, v46
    v_exp_f32 v47, v47
    v_exp_f32 v16, v16
    v_exp_f32 v17, v17
    v_smfmac_f32_32x32x32_bf16 v[112:127], v[108:111], v[40:47], v2
    s_mov_b64 exec, s[44:45]
    s_waitcnt lgkmcnt(0)
    ds_read_b128 v[100:103], v4 offset:3072
    ds_read_b128 v[108:111], v4 offset:3584
    s_mov_b64 exec, -1
    ds_read_b128 v[88:91], v3 offset:4096
    v_exp_f32 v18, v18
    v_exp_f32 v19, v19
    v_exp_f32 v20, v20
    v_mfma_f32_32x32x16_bf16 v[32:47], v[92:95], v[84:87], v[64:79]
    s_setprio 3
    v_exp_f32 v21, v21
    v_exp_f32 v22, v22
    v_exp_f32 v23, v23
    v_exp_f32 v24, v24
    v_exp_f32 v25, v25
    v_smfmac_f32_32x32x32_bf16 v[112:127], v[96:99], v[16:23], v2
    s_lshl_b32 s51, s3, 12
    s_add_u32 m0, s51, 65536
    s_add_u32 s93, s51, 4292608
    buffer_load_dwordx4 v6, s[24:27], s93 offen offset:0 sc1 lds
    v_exp_f32 v26, v26
    v_exp_f32 v27, v27
    v_exp_f32 v28, v28
    v_exp_f32 v29, v29
    v_exp_f32 v30, v30
    v_exp_f32 v31, v31
    v_exp_f32 v32, v32
    v_exp_f32 v33, v33
    v_smfmac_f32_32x32x32_bf16 v[112:127], v[104:107], v[24:31], v2
    s_mov_b64 exec, s[44:45]
    s_waitcnt lgkmcnt(0)
    ds_read_b128 v[96:99], v4 offset:4096
    ds_read_b128 v[104:107], v4 offset:4608
    s_mov_b64 exec, -1
    ds_read_b128 v[92:95], v3 offset:5120
    v_exp_f32 v34, v34
    v_exp_f32 v35, v35
    v_exp_f32 v36, v36
    v_mfma_f32_32x32x16_bf16 v[16:31], v[88:91], v[84:87], v[64:79]
    v_exp_f32 v37, v37
    v_exp_f32 v38, v38
    v_exp_f32 v39, v39
    v_exp_f32 v40, v40
    v_exp_f32 v41, v41
    v_smfmac_f32_32x32x32_bf16 v[112:127], v[100:103], v[32:39], v2
    buffer_load_dwordx4 v6, s[24:27], s93 offen offset:1024 sc1 lds
    v_exp_f32 v42, v42
    v_exp_f32 v43, v43
    v_exp_f32 v44, v44
    v_exp_f32 v45, v45
    v_exp_f32 v46, v46
    v_exp_f32 v47, v47
    v_exp_f32 v16, v16
    v_exp_f32 v17, v17
    v_smfmac_f32_32x32x32_bf16 v[112:127], v[108:111], v[40:47], v2
    s_mov_b64 exec, s[44:45]
    s_waitcnt lgkmcnt(0)
    ds_read_b128 v[100:103], v4 offset:5120
    ds_read_b128 v[108:111], v4 offset:5632
    s_mov_b64 exec, -1
    ds_read_b128 v[88:91], v3 offset:6144
    v_exp_f32 v18, v18
    v_exp_f32 v19, v19
    v_exp_f32 v20, v20
    v_mfma_f32_32x32x16_bf16 v[32:47], v[92:95], v[84:87], v[64:79]
    v_exp_f32 v21, v21
    v_exp_f32 v22, v22
    v_exp_f32 v23, v23
    v_exp_f32 v24, v24
    v_exp_f32 v25, v25
    v_smfmac_f32_32x32x32_bf16 v[112:127], v[96:99], v[16:23], v2
    buffer_load_dwordx4 v6, s[24:27], s93 offen offset:2048 sc1 lds
    v_exp_f32 v26, v26
    v_exp_f32 v27, v27
    v_exp_f32 v28, v28
    v_exp_f32 v29, v29
    v_exp_f32 v30, v30
    v_exp_f32 v31, v31
    v_exp_f32 v32, v32
    v_exp_f32 v33, v33
    v_smfmac_f32_32x32x32_bf16 v[112:127], v[104:107], v[24:31], v2
    s_mov_b64 exec, s[44:45]
    s_waitcnt lgkmcnt(0)
    ds_read_b128 v[96:99], v4 offset:6144
    ds_read_b128 v[104:107], v4 offset:6656
    s_mov_b64 exec, -1
    ds_read_b128 v[92:95], v3 offset:7168
    v_exp_f32 v34, v34
    v_exp_f32 v35, v35
    v_exp_f32 v36, v36
    v_mfma_f32_32x32x16_bf16 v[16:31], v[88:91], v[84:87], v[64:79]
    v_exp_f32 v37, v37
    v_exp_f32 v38, v38
    v_exp_f32 v39, v39
    v_exp_f32 v40, v40
    v_exp_f32 v41, v41
    v_smfmac_f32_32x32x32_bf16 v[112:127], v[100:103], v[32:39], v2
    s_setprio 2
    buffer_load_dwordx4 v6, s[24:27], s93 offen offset:3072 sc1 lds
    v_exp_f32 v42, v42
    v_exp_f32 v43, v43
    v_exp_f32 v44, v44
    v_exp_f32 v45, v45
    v_exp_f32 v46, v46
    v_exp_f32 v47, v47
    v_add_u32 v3, 4294819840, v3
    v_exp_f32 v16, v16
    v_exp_f32 v17, v17
    v_smfmac_f32_32x32x32_bf16 v[112:127], v[108:111], v[40:47], v2
    s_mov_b64 exec, s[44:45]
    s_waitcnt lgkmcnt(0)
    ds_read_b128 v[100:103], v4 offset:7168
    ds_read_b128 v[108:111], v4 offset:7680
    s_mov_b64 exec, -1
    ds_read_b128 v[88:91], v3 offset:0
    v_exp_f32 v18, v18
    v_exp_f32 v19, v19
    v_exp_f32 v20, v20
    v_mfma_f32_32x32x16_bf16 v[32:47], v[92:95], v[84:87], v[64:79]
    v_exp_f32 v21, v21
    v_exp_f32 v22, v22
    v_exp_f32 v23, v23
    v_exp_f32 v24, v24
    v_exp_f32 v25, v25
    v_smfmac_f32_32x32x32_bf16 v[112:127], v[96:99], v[16:23], v2
    v_exp_f32 v26, v26
    v_exp_f32 v27, v27
    v_exp_f32 v28, v28
    v_exp_f32 v29, v29
    v_exp_f32 v30, v30
    v_exp_f32 v31, v31
    v_add_u32 v4, 4294819840, v4
    v_exp_f32 v32, v32
    v_exp_f32 v33, v33
    v_smfmac_f32_32x32x32_bf16 v[112:127], v[104:107], v[24:31], v2
    s_mov_b64 exec, s[44:45]
    s_waitcnt lgkmcnt(0)
    ds_read_b128 v[96:99], v4 offset:0
    ds_read_b128 v[104:107], v4 offset:512
    s_mov_b64 exec, -1
    ds_read_b128 v[92:95], v3 offset:1024
    v_exp_f32 v34, v34
    v_exp_f32 v35, v35
    v_exp_f32 v36, v36
    v_mfma_f32_32x32x16_bf16 v[16:31], v[88:91], v[84:87], v[64:79]
    v_exp_f32 v37, v37
    v_exp_f32 v38, v38
    v_exp_f32 v39, v39
    v_exp_f32 v40, v40
    v_exp_f32 v41, v41
    v_smfmac_f32_32x32x32_bf16 v[112:127], v[100:103], v[32:39], v2
    v_exp_f32 v42, v42
    v_exp_f32 v43, v43
    v_exp_f32 v44, v44
    v_exp_f32 v45, v45
    v_exp_f32 v46, v46
    v_exp_f32 v47, v47
    v_exp_f32 v16, v16
    v_exp_f32 v17, v17
    v_smfmac_f32_32x32x32_bf16 v[112:127], v[108:111], v[40:47], v2
    s_mov_b64 exec, s[44:45]
    s_waitcnt lgkmcnt(0)
    ds_read_b128 v[100:103], v4 offset:1024
    ds_read_b128 v[108:111], v4 offset:1536
    s_mov_b64 exec, -1
    ds_read_b128 v[88:91], v3 offset:2048
    v_exp_f32 v18, v18
    v_exp_f32 v19, v19
    v_exp_f32 v20, v20
    v_mfma_f32_32x32x16_bf16 v[32:47], v[92:95], v[84:87], v[64:79]
    v_exp_f32 v21, v21
    v_exp_f32 v22, v22
    v_exp_f32 v23, v23
    v_exp_f32 v24, v24
    v_exp_f32 v25, v25
    v_smfmac_f32_32x32x32_bf16 v[112:127], v[96:99], v[16:23], v2
    s_setprio 1
    v_exp_f32 v26, v26
    v_exp_f32 v27, v27
    v_exp_f32 v28, v28
    v_exp_f32 v29, v29
    v_exp_f32 v30, v30
    v_exp_f32 v31, v31
    v_exp_f32 v32, v32
    v_exp_f32 v33, v33
    v_smfmac_f32_32x32x32_bf16 v[112:127], v[104:107], v[24:31], v2
    s_mov_b64 exec, s[44:45]
    s_waitcnt lgkmcnt(0)
    ds_read_b128 v[96:99], v4 offset:2048
    ds_read_b128 v[104:107], v4 offset:2560
    s_mov_b64 exec, -1
    ds_read_b128 v[92:95], v3 offset:3072
    v_exp_f32 v34, v34
    v_exp_f32 v35, v35
    v_exp_f32 v36, v36
    v_mfma_f32_32x32x16_bf16 v[16:31], v[88:91], v[84:87], v[64:79]
    s_setprio 0
    v_exp_f32 v37, v37
    v_exp_f32 v38, v38
    v_exp_f32 v39, v39
    v_exp_f32 v40, v40
    v_exp_f32 v41, v41
    v_smfmac_f32_32x32x32_bf16 v[112:127], v[100:103], v[32:39], v2
    s_waitcnt vmcnt(7)
    s_barrier
    v_exp_f32 v42, v42
    v_exp_f32 v43, v43
    v_exp_f32 v44, v44
    v_exp_f32 v45, v45
    v_exp_f32 v46, v46
    v_exp_f32 v47, v47
    v_exp_f32 v16, v16
    v_exp_f32 v17, v17
    v_smfmac_f32_32x32x32_bf16 v[112:127], v[108:111], v[40:47], v2
    s_mov_b64 exec, s[44:45]
    s_waitcnt lgkmcnt(0)
    ds_read_b128 v[100:103], v4 offset:3072
    ds_read_b128 v[108:111], v4 offset:3584
    s_mov_b64 exec, -1
    ds_read_b128 v[88:91], v3 offset:4096
    v_exp_f32 v18, v18
    v_exp_f32 v19, v19
    v_exp_f32 v20, v20
    v_mfma_f32_32x32x16_bf16 v[32:47], v[92:95], v[84:87], v[64:79]
    s_setprio 3
    v_exp_f32 v21, v21
    s_cmp_eq_u32 s3, 0
    s_cbranch_scc1 L_rare_49
L_back_50:
    v_exp_f32 v22, v22
    v_exp_f32 v23, v23
    v_exp_f32 v24, v24
    v_exp_f32 v25, v25
    v_smfmac_f32_32x32x32_bf16 v[112:127], v[96:99], v[16:23], v2
    v_exp_f32 v26, v26
    v_exp_f32 v27, v27
    v_exp_f32 v28, v28
    v_exp_f32 v29, v29
    v_exp_f32 v30, v30
    v_exp_f32 v31, v31
    v_exp_f32 v32, v32
    v_exp_f32 v33, v33
    v_smfmac_f32_32x32x32_bf16 v[112:127], v[104:107], v[24:31], v2
    s_mov_b64 exec, s[44:45]
    s_waitcnt lgkmcnt(0)
    ds_read_b128 v[96:99], v4 offset:4096
    ds_read_b128 v[104:107], v4 offset:4608
    s_mov_b64 exec, -1
    ds_read_b128 v[92:95], v3 offset:5120
    v_exp_f32 v34, v34
    v_exp_f32 v35, v35
    v_exp_f32 v36, v36
    v_mfma_f32_32x32x16_bf16 v[16:31], v[88:91], v[84:87], v[64:79]
    v_exp_f32 v37, v37
    v_exp_f32 v38, v38
    v_exp_f32 v39, v39
    v_exp_f32 v40, v40
    v_exp_f32 v41, v41
    v_smfmac_f32_32x32x32_bf16 v[112:127], v[100:103], v[32:39], v2
    v_exp_f32 v42, v42
    v_exp_f32 v43, v43
    v_exp_f32 v44, v44
    v_exp_f32 v45, v45
    v_exp_f32 v46, v46
    v_exp_f32 v47, v47
    v_exp_f32 v16, v16
    v_exp_f32 v17, v17
    v_smfmac_f32_32x32x32_bf16 v[112:127], v[108:111], v[40:47], v2
    s_mov_b64 exec, s[44:45]
    s_waitcnt lgkmcnt(0)
    ds_read_b128 v[100:103], v4 offset:5120
    ds_read_b128 v[108:111], v4 offset:5632
    s_mov_b64 exec, -1
    ds_read_b128 v[88:91], v3 offset:6144
    v_exp_f32 v18, v18
    v_exp_f32 v19, v19
    v_exp_f32 v20, v20
    v_mfma_f32_32x32x16_bf16 v[32:47], v[92:95], v[84:87], v[64:79]
    v_exp_f32 v21, v21
    v_exp_f32 v22, v22
    v_exp_f32 v23, v23
    v_exp_f32 v24, v24
    v_exp_f32 v25, v25
    v_smfmac_f32_32x32x32_bf16 v[112:127], v[96:99], v[16:23], v2
    v_exp_f32 v26, v26
    v_exp_f32 v27, v27
    v_exp_f32 v28, v28
    v_exp_f32 v29, v29
    v_exp_f32 v30, v30
    v_exp_f32 v31, v31
    v_exp_f32 v32, v32
    v_exp_f32 v33, v33
    v_smfmac_f32_32x32x32_bf16 v[112:127], v[104:107], v[24:31], v2
    s_mov_b64 exec, s[44:45]
    s_waitcnt lgkmcnt(0)
    ds_read_b128 v[96:99], v4 offset:6144
    ds_read_b128 v[104:107], v4 offset:6656
    s_mov_b64 exec, -1
    ds_read_b128 v[92:95], v3 offset:7168
    v_exp_f32 v34, v34
    v_exp_f32 v35, v35
    v_exp_f32 v36, v36
    v_mfma_f32_32x32x16_bf16 v[16:31], v[88:91], v[84:87], v[64:79]
    v_exp_f32 v37, v37
    v_exp_f32 v38, v38
    v_exp_f32 v39, v39
    v_exp_f32 v40, v40
    v_exp_f32 v41, v41
    v_smfmac_f32_32x32x32_bf16 v[112:127], v[100:103], v[32:39], v2
    s_setprio 2
    v_exp_f32 v42, v42
    v_exp_f32 v43, v43
    v_exp_f32 v44, v44
    v_exp_f32 v45, v45
    v_exp_f32 v46, v46
    v_exp_f32 v47, v47
    v_add_u32 v3, 16384, v3
    v_exp_f32 v16, v16
    v_exp_f32 v17, v17
    v_smfmac_f32_32x32x32_bf16 v[112:127], v[108:111], v[40:47], v2
    s_mov_b64 exec, s[44:45]
    s_waitcnt lgkmcnt(0)
    ds_read_b128 v[100:103], v4 offset:7168
    ds_read_b128 v[108:111], v4 offset:7680
    s_mov_b64 exec, -1
    ds_read_b128 v[88:91], v3 offset:0
    v_exp_f32 v18, v18
    v_exp_f32 v19, v19
    v_exp_f32 v20, v20
    v_mfma_f32_32x32x16_bf16 v[32:47], v[92:95], v[84:87], v[64:79]
    v_exp_f32 v21, v21
    v_exp_f32 v22, v22
    v_exp_f32 v23, v23
    v_exp_f32 v24, v24
    v_mov_b32 v8, v120
    v_mov_b32 v9, v120
    v_exp_f32 v25, v25
    v_smfmac_f32_32x32x32_bf16 v[112:127], v[96:99], v[16:23], v2
    v_exp_f32 v26, v26
    v_permlane32_swap_b32 v8, v9
    v_exp_f32 v27, v27
    v_frexp_exp_i32_f32 v8, v8
    v_add_u32 v8, 101, v8
    v_min_i32 v8, 0x78, v8
    v_cvt_f32_i32 v9, v8
    v_sub_u32 v8, 0, v8
    v_ldexp_f32 v10, 1.0, v8
    v_exp_f32 v28, v28
    v_sub_f32 v64, v64, v9
    v_sub_f32 v65, v65, v9
    v_mov_b64 v[66:67], v[64:65]
    v_mov_b64 v[68:69], v[64:65]
    v_mov_b64 v[70:71], v[64:65]
    v_mov_b64 v[72:73], v[64:65]
    v_mov_b64 v[74:75], v[64:65]
    v_mov_b64 v[76:77], v[64:65]
    v_mov_b64 v[78:79], v[64:65]
    v_exp_f32 v29, v29
    v_exp_f32 v30, v30
    v_exp_f32 v31, v31
    v_add_u32 v4, 16384, v4
    v_exp_f32 v32, v32
    v_exp_f32 v33, v33
    v_smfmac_f32_32x32x32_bf16 v[112:127], v[104:107], v[24:31], v2
    s_mov_b64 exec, s[44:45]
    s_waitcnt lgkmcnt(0)
    ds_read_b128 v[96:99], v4 offset:0
    ds_read_b128 v[104:107], v4 offset:512
    s_mov_b64 exec, -1
    ds_read_b128 v[92:95], v3 offset:1024
    v_exp_f32 v34, v34
    v_exp_f32 v35, v35
    v_exp_f32 v36, v36
    v_mfma_f32_32x32x16_bf16 v[16:31], v[88:91], v[84:87], v[64:79]
    v_exp_f32 v37, v37
    v_exp_f32 v38, v38
    v_exp_f32 v39, v39
    v_exp_f32 v40, v40
    v_exp_f32 v41, v41
    v_smfmac_f32_32x32x32_bf16 v[112:127], v[100:103], v[32:39], v2
    v_exp_f32 v42, v42
    v_exp_f32 v43, v43
    v_exp_f32 v44, v44
    v_exp_f32 v45, v45
    v_exp_f32 v46, v46
    v_exp_f32 v47, v47
    v_exp_f32 v16, v16
    v_exp_f32 v17, v17
    v_smfmac_f32_32x32x32_bf16 v[112:127], v[108:111], v[40:47], v2
    s_mov_b64 exec, s[44:45]
    s_waitcnt lgkmcnt(0)
    ds_read_b128 v[100:103], v4 offset:1024
    ds_read_b128 v[108:111], v4 offset:1536
    s_mov_b64 exec, -1
    ds_read_b128 v[88:91], v3 offset:2048
    v_exp_f32 v18, v18
    v_exp_f32 v19, v19
    v_exp_f32 v20, v20
    v_mfma_f32_32x32x16_bf16 v[32:47], v[92:95], v[84:87], v[64:79]
    v_exp_f32 v21, v21
    v_exp_f32 v22, v22
    v_exp_f32 v23, v23
    v_exp_f32 v24, v24
    v_pk_mul_f32 v[112:113], v[112:113], v[10:11] op_sel_hi:[1,0]
    v_pk_mul_f32 v[114:115], v[114:115], v[10:11] op_sel_hi:[1,0]
    v_pk_mul_f32 v[116:117], v[116:117], v[10:11] op_sel_hi:[1,0]
    v_pk_mul_f32 v[118:119], v[118:119], v[10:11] op_sel_hi:[1,0]
    v_mul_f32 v120, v10, v120
    s_nop 0
    v_exp_f32 v25, v25
    v_smfmac_f32_32x32x32_bf16 v[112:127], v[96:99], v[16:23], v2
    s_setprio 1
    v_exp_f32 v26, v26
    v_exp_f32 v27, v27
    v_exp_f32 v28, v28
    v_exp_f32 v29, v29
    v_exp_f32 v30, v30
    v_exp_f32 v31, v31
    v_exp_f32 v32, v32
    v_exp_f32 v33, v33
    v_smfmac_f32_32x32x32_bf16 v[112:127], v[104:107], v[24:31], v2
    s_mov_b64 exec, s[44:45]
    s_waitcnt lgkmcnt(0)
    ds_read_b128 v[96:99], v4 offset:2048
    ds_read_b128 v[104:107], v4 offset:2560
    s_mov_b64 exec, -1
    ds_read_b128 v[92:95], v3 offset:3072
    v_exp_f32 v34, v34
    v_exp_f32 v35, v35
    v_exp_f32 v36, v36
    v_mfma_f32_32x32x16_bf16 v[16:31], v[88:91], v[84:87], v[64:79]
    s_setprio 0
    v_exp_f32 v37, v37
    v_exp_f32 v38, v38
    v_exp_f32 v39, v39
    v_exp_f32 v40, v40
    v_exp_f32 v41, v41
    v_smfmac_f32_32x32x32_bf16 v[112:127], v[100:103], v[32:39], v2
    s_waitcnt vmcnt(0)
    s_barrier
    v_exp_f32 v42, v42
    v_exp_f32 v43, v43
    v_exp_f32 v44, v44
    v_exp_f32 v45, v45
    v_exp_f32 v46, v46
    v_exp_f32 v47, v47
    v_exp_f32 v16, v16
    v_exp_f32 v17, v17
    v_smfmac_f32_32x32x32_bf16 v[112:127], v[108:111], v[40:47], v2
    s_mov_b64 exec, s[44:45]
    s_waitcnt lgkmcnt(0)
    ds_read_b128 v[100:103], v4 offset:3072
    ds_read_b128 v[108:111], v4 offset:3584
    s_mov_b64 exec, -1
    ds_read_b128 v[88:91], v3 offset:4096
    v_exp_f32 v18, v18
    v_exp_f32 v19, v19
    v_exp_f32 v20, v20
    v_mfma_f32_32x32x16_bf16 v[32:47], v[92:95], v[84:87], v[64:79]
    s_setprio 3
    v_exp_f32 v21, v21
    v_exp_f32 v22, v22
    v_exp_f32 v23, v23
    v_exp_f32 v24, v24
    v_exp_f32 v25, v25
    v_smfmac_f32_32x32x32_bf16 v[112:127], v[96:99], v[16:23], v2
    v_exp_f32 v26, v26
    v_exp_f32 v27, v27
    v_exp_f32 v28, v28
    v_exp_f32 v29, v29
    v_exp_f32 v30, v30
    v_exp_f32 v31, v31
    v_exp_f32 v32, v32
    v_exp_f32 v33, v33
    v_smfmac_f32_32x32x32_bf16 v[112:127], v[104:107], v[24:31], v2
    s_mov_b64 exec, s[44:45]
    s_waitcnt lgkmcnt(0)
    ds_read_b128 v[96:99], v4 offset:4096
    ds_read_b128 v[104:107], v4 offset:4608
    s_mov_b64 exec, -1
    ds_read_b128 v[92:95], v3 offset:5120
    v_exp_f32 v34, v34
    v_exp_f32 v35, v35
    v_exp_f32 v36, v36
    v_mfma_f32_32x32x16_bf16 v[16:31], v[88:91], v[84:87], v[64:79]
    v_exp_f32 v37, v37
    v_exp_f32 v38, v38
    v_exp_f32 v39, v39
    v_exp_f32 v40, v40
    v_exp_f32 v41, v41
    v_smfmac_f32_32x32x32_bf16 v[112:127], v[100:103], v[32:39], v2
    v_exp_f32 v42, v42
    v_exp_f32 v43, v43
    v_exp_f32 v44, v44
    v_exp_f32 v45, v45
    v_exp_f32 v46, v46
    v_exp_f32 v47, v47
    v_exp_f32 v16, v16
    v_exp_f32 v17, v17
    v_smfmac_f32_32x32x32_bf16 v[112:127], v[108:111], v[40:47], v2
    s_mov_b64 exec, s[44:45]
    s_waitcnt lgkmcnt(0)
    ds_read_b128 v[100:103], v4 offset:5120
    ds_read_b128 v[108:111], v4 offset:5632
    s_mov_b64 exec, -1
    ds_read_b128 v[88:91], v3 offset:6144
    v_exp_f32 v18, v18
    v_exp_f32 v19, v19
    v_exp_f32 v20, v20
    v_mfma_f32_32x32x16_bf16 v[32:47], v[92:95], v[84:87], v[64:79]
    v_exp_f32 v21, v21
    s_cmp_eq_u32 s3, 0
    s_cbranch_scc1 L_rare_51
L_back_52:
    v_exp_f32 v22, v22
    v_exp_f32 v23, v23
    v_exp_f32 v24, v24
    v_exp_f32 v25, v25
    v_smfmac_f32_32x32x32_bf16 v[112:127], v[96:99], v[16:23], v2
    v_exp_f32 v26, v26
    v_exp_f32 v27, v27
    v_exp_f32 v28, v28
    v_exp_f32 v29, v29
    v_exp_f32 v30, v30
    v_exp_f32 v31, v31
    v_exp_f32 v32, v32
    v_exp_f32 v33, v33
    v_smfmac_f32_32x32x32_bf16 v[112:127], v[104:107], v[24:31], v2
    s_mov_b64 exec, s[44:45]
    s_waitcnt lgkmcnt(0)
    ds_read_b128 v[96:99], v4 offset:6144
    ds_read_b128 v[104:107], v4 offset:6656
    s_mov_b64 exec, -1
    ds_read_b128 v[92:95], v3 offset:7168
    v_exp_f32 v34, v34
    v_exp_f32 v35, v35
    v_exp_f32 v36, v36
    v_mfma_f32_32x32x16_bf16 v[16:31], v[88:91], v[84:87], v[64:79]
    v_exp_f32 v37, v37
    v_exp_f32 v38, v38
    v_exp_f32 v39, v39
    v_exp_f32 v40, v40
    v_exp_f32 v41, v41
    v_smfmac_f32_32x32x32_bf16 v[112:127], v[100:103], v[32:39], v2
    s_setprio 2
    v_exp_f32 v42, v42
    v_exp_f32 v43, v43
    v_exp_f32 v44, v44
    v_exp_f32 v45, v45
    v_exp_f32 v46, v46
    v_exp_f32 v47, v47
    v_add_u32 v3, 16384, v3
    v_exp_f32 v16, v16
    v_exp_f32 v17, v17
    v_smfmac_f32_32x32x32_bf16 v[112:127], v[108:111], v[40:47], v2
    s_mov_b64 exec, s[44:45]
    s_waitcnt lgkmcnt(0)
    ds_read_b128 v[100:103], v4 offset:7168
    ds_read_b128 v[108:111], v4 offset:7680
    s_mov_b64 exec, -1
    ds_read_b128 v[88:91], v3 offset:0
    v_exp_f32 v18, v18
    v_exp_f32 v19, v19
    v_exp_f32 v20, v20
    v_mfma_f32_32x32x16_bf16 v[32:47], v[92:95], v[84:87], v[64:79]
    v_exp_f32 v21, v21
    v_exp_f32 v22, v22
    v_exp_f32 v23, v23
    v_exp_f32 v24, v24
    v_exp_f32 v25, v25
    v_smfmac_f32_32x32x32_bf16 v[112:127], v[96:99], v[16:23], v2
    v_exp_f32 v26, v26
    v_exp_f32 v27, v27
    v_exp_f32 v28, v28
    v_exp_f32 v29, v29
    v_exp_f32 v30, v30
    v_exp_f32 v31, v31
    v_add_u32 v4, 16384, v4
    v_exp_f32 v32, v32
    v_exp_f32 v33, v33
    v_smfmac_f32_32x32x32_bf16 v[112:127], v[104:107], v[24:31], v2
    s_mov_b64 exec, s[44:45]
    s_waitcnt lgkmcnt(0)
    ds_read_b128 v[96:99], v4 offset:0
    ds_read_b128 v[104:107], v4 offset:512
    s_mov_b64 exec, -1
    ds_read_b128 v[92:95], v3 offset:1024
    v_exp_f32 v34, v34
    v_exp_f32 v35, v35
    v_exp_f32 v36, v36
    v_mfma_f32_32x32x16_bf16 v[16:31], v[88:91], v[84:87], v[64:79]
    v_exp_f32 v37, v37
    v_exp_f32 v38, v38
    v_exp_f32 v39, v39
    v_exp_f32 v40, v40
    v_exp_f32 v41, v41
    v_smfmac_f32_32x32x32_bf16 v[112:127], v[100:103], v[32:39], v2
    v_exp_f32 v42, v42
    v_exp_f32 v43, v43
    v_exp_f32 v44, v44
    v_exp_f32 v45, v45
    v_exp_f32 v46, v46
    v_exp_f32 v47, v47
    v_exp_f32 v16, v16
    v_exp_f32 v17, v17
    v_smfmac_f32_32x32x32_bf16 v[112:127], v[108:111], v[40:47], v2
    s_mov_b64 exec, s[44:45]
    s_waitcnt lgkmcnt(0)
    ds_read_b128 v[100:103], v4 offset:1024
    ds_read_b128 v[108:111], v4 offset:1536
    s_mov_b64 exec, -1
    ds_read_b128 v[88:91], v3 offset:2048
    v_exp_f32 v18, v18
    v_exp_f32 v19, v19
    v_exp_f32 v20, v20
    v_mfma_f32_32x32x16_bf16 v[32:47], v[92:95], v[84:87], v[64:79]
    v_exp_f32 v21, v21
    v_exp_f32 v22, v22
    v_exp_f32 v23, v23
    v_exp_f32 v24, v24
    v_exp_f32 v25, v25
    v_smfmac_f32_32x32x32_bf16 v[112:127], v[96:99], v[16:23], v2
    s_setprio 1
    v_exp_f32 v26, v26
    v_exp_f32 v27, v27
    v_exp_f32 v28, v28
    v_exp_f32 v29, v29
    v_exp_f32 v30, v30
    v_exp_f32 v31, v31
    v_exp_f32 v32, v32
    s_waitcnt vmcnt(0)
    s_cmp_eq_u32 s3, 0
    s_cbranch_scc1 L_rare_53
L_back_54:
    v_exp_f32 v33, v33
    v_smfmac_f32_32x32x32_bf16 v[112:127], v[104:107], v[24:31], v2
    s_mov_b64 exec, s[44:45]
    s_waitcnt lgkmcnt(0)
    ds_read_b128 v[96:99], v4 offset:2048
    ds_read_b128 v[104:107], v4 offset:2560
    s_mov_b64 exec, -1
    ds_read_b128 v[92:95], v3 offset:3072
    v_exp_f32 v34, v34
    v_exp_f32 v35, v35
    v_exp_f32 v36, v36
    v_mfma_f32_32x32x16_bf16 v[16:31], v[88:91], v[84:87], v[64:79]
    s_setprio 0
    v_exp_f32 v37, v37
    v_exp_f32 v38, v38
    v_exp_f32 v39, v39
    v_exp_f32 v40, v40
    v_exp_f32 v41, v41
    v_smfmac_f32_32x32x32_bf16 v[112:127], v[100:103], v[32:39], v2
    s_waitcnt vmcnt(0)
    s_barrier
    v_exp_f32 v42, v42
    v_exp_f32 v43, v43
    v_exp_f32 v44, v44
    v_exp_f32 v45, v45
    v_exp_f32 v46, v46
    v_exp_f32 v47, v47
    v_exp_f32 v16, v16
    v_exp_f32 v17, v17
    v_smfmac_f32_32x32x32_bf16 v[112:127], v[108:111], v[40:47], v2
    s_mov_b64 exec, s[44:45]
    s_waitcnt lgkmcnt(0)
    ds_read_b128 v[100:103], v4 offset:3072
    ds_read_b128 v[108:111], v4 offset:3584
    s_mov_b64 exec, -1
    ds_read_b128 v[88:91], v3 offset:4096
    v_exp_f32 v18, v18
    v_exp_f32 v19, v19
    v_exp_f32 v20, v20
    v_mfma_f32_32x32x16_bf16 v[32:47], v[92:95], v[84:87], v[64:79]
    s_setprio 3
    v_exp_f32 v21, v21
    v_exp_f32 v22, v22
    v_exp_f32 v23, v23
    v_exp_f32 v24, v24
    v_exp_f32 v25, v25
    v_smfmac_f32_32x32x32_bf16 v[112:127], v[96:99], v[16:23], v2
    s_lshl_b32 s51, s3, 12
    s_add_u32 m0, s51, 98304
    s_add_u32 s93, s89, 0
    buffer_load_dwordx4 v6, s[24:27], s93 offen offset:0 sc1 lds
    v_exp_f32 v26, v26
    v_exp_f32 v27, v27
    v_exp_f32 v28, v28
    v_exp_f32 v29, v29
    v_exp_f32 v30, v30
    v_exp_f32 v31, v31
    v_exp_f32 v32, v32
    v_exp_f32 v33, v33
    v_smfmac_f32_32x32x32_bf16 v[112:127], v[104:107], v[24:31], v2
    s_mov_b64 exec, s[44:45]
    s_waitcnt lgkmcnt(0)
    ds_read_b128 v[96:99], v4 offset:4096
    ds_read_b128 v[104:107], v4 offset:4608
    s_mov_b64 exec, -1
    ds_read_b128 v[92:95], v3 offset:5120
    v_exp_f32 v34, v34
    v_exp_f32 v35, v35
    v_exp_f32 v36, v36
    v_mfma_f32_32x32x16_bf16 v[16:31], v[88:91], v[84:87], v[64:79]
    v_exp_f32 v37, v37
    v_exp_f32 v38, v38
    v_exp_f32 v39, v39
    v_exp_f32 v40, v40
    v_exp_f32 v41, v41
    v_smfmac_f32_32x32x32_bf16 v[112:127], v[100:103], v[32:39], v2
    buffer_load_dwordx4 v6, s[24:27], s93 offen offset:1024 sc1 lds
    v_exp_f32 v42, v42
    v_exp_f32 v43, v43
    v_exp_f32 v44, v44
    v_exp_f32 v45, v45
    v_exp_f32 v46, v46
    v_exp_f32 v47, v47
    v_exp_f32 v16, v16
    v_exp_f32 v17, v17
    v_smfmac_f32_32x32x32_bf16 v[112:127], v[108:111], v[40:47], v2
    s_mov_b64 exec, s[44:45]
    s_waitcnt lgkmcnt(0)
    ds_read_b128 v[100:103], v4 offset:5120
    ds_read_b128 v[108:111], v4 offset:5632
    s_mov_b64 exec, -1
    ds_read_b128 v[88:91], v3 offset:6144
    v_exp_f32 v18, v18
    v_exp_f32 v19, v19
    v_exp_f32 v20, v20
    v_mfma_f32_32x32x16_bf16 v[32:47], v[92:95], v[84:87], v[64:79]
    v_exp_f32 v21, v21
    v_exp_f32 v22, v22
    v_exp_f32 v23, v23
    v_exp_f32 v24, v24
    v_exp_f32 v25, v25
    v_smfmac_f32_32x32x32_bf16 v[112:127], v[96:99], v[16:23], v2
    buffer_load_dwordx4 v6, s[24:27], s93 offen offset:2048 sc1 lds
    v_exp_f32 v26, v26
    v_exp_f32 v27, v27
    v_exp_f32 v28, v28
    v_exp_f32 v29, v29
    v_exp_f32 v30, v30
    v_exp_f32 v31, v31
    v_exp_f32 v32, v32
    v_exp_f32 v33, v33
    v_smfmac_f32_32x32x32_bf16 v[112:127], v[104:107], v[24:31], v2
    s_mov_b64 exec, s[44:45]
    s_waitcnt lgkmcnt(0)
    ds_read_b128 v[96:99], v4 offset:6144
    ds_read_b128 v[104:107], v4 offset:6656
    s_mov_b64 exec, -1
    ds_read_b128 v[92:95], v3 offset:7168
    v_exp_f32 v34, v34
    v_exp_f32 v35, v35
    v_exp_f32 v36, v36
    v_mfma_f32_32x32x16_bf16 v[16:31], v[88:91], v[84:87], v[64:79]
    v_exp_f32 v37, v37
    v_exp_f32 v38, v38
    v_exp_f32 v39, v39
    v_exp_f32 v40, v40
    v_exp_f32 v41, v41
    v_smfmac_f32_32x32x32_bf16 v[112:127], v[100:103], v[32:39], v2
    s_setprio 2
    buffer_load_dwordx4 v6, s[24:27], s93 offen offset:3072 sc1 lds
    v_exp_f32 v42, v42
    v_exp_f32 v43, v43
    v_exp_f32 v44, v44
    v_exp_f32 v45, v45
    v_exp_f32 v46, v46
    v_exp_f32 v47, v47
    v_add_u32 v3, 16384, v3
    v_exp_f32 v16, v16
    v_exp_f32 v17, v17
    v_smfmac_f32_32x32x32_bf16 v[112:127], v[108:111], v[40:47], v2
    s_mov_b64 exec, s[44:45]
    s_waitcnt lgkmcnt(0)
    ds_read_b128 v[100:103], v4 offset:7168
    ds_read_b128 v[108:111], v4 offset:7680
    s_mov_b64 exec, -1
    ds_read_b128 v[88:91], v3 offset:0
    v_exp_f32 v18, v18
    v_exp_f32 v19, v19
    v_exp_f32 v20, v20
    v_mfma_f32_32x32x16_bf16 v[32:47], v[92:95], v[84:87], v[64:79]
    v_exp_f32 v21, v21
    v_exp_f32 v22, v22
    v_exp_f32 v23, v23
    v_exp_f32 v24, v24
    v_exp_f32 v25, v25
    v_smfmac_f32_32x32x32_bf16 v[112:127], v[96:99], v[16:23], v2
    v_exp_f32 v26, v26
    v_exp_f32 v27, v27
    v_exp_f32 v28, v28
    v_exp_f32 v29, v29
    v_exp_f32 v30, v30
    v_exp_f32 v31, v31
    v_add_u32 v4, 16384, v4
    v_exp_f32 v32, v32
    v_exp_f32 v33, v33
    v_smfmac_f32_32x32x32_bf16 v[112:127], v[104:107], v[24:31], v2
    s_mov_b64 exec, s[44:45]
    s_waitcnt lgkmcnt(0)
    ds_read_b128 v[96:99], v4 offset:0
    ds_read_b128 v[104:107], v4 offset:512
    s_mov_b64 exec, -1
    ds_read_b128 v[92:95], v3 offset:1024
    v_exp_f32 v34, v34
    v_exp_f32 v35, v35
    v_exp_f32 v36, v36
    v_mfma_f32_32x32x16_bf16 v[16:31], v[88:91], v[84:87], v[64:79]
    v_exp_f32 v37, v37
    v_exp_f32 v38, v38
    v_exp_f32 v39, v39
    v_exp_f32 v40, v40
    v_exp_f32 v41, v41
    v_smfmac_f32_32x32x32_bf16 v[112:127], v[100:103], v[32:39], v2
    v_exp_f32 v42, v42
    v_exp_f32 v43, v43
    v_exp_f32 v44, v44
    v_exp_f32 v45, v45
    v_exp_f32 v46, v46
    v_exp_f32 v47, v47
    v_exp_f32 v16, v16
    v_exp_f32 v17, v17
    v_smfmac_f32_32x32x32_bf16 v[112:127], v[108:111], v[40:47], v2
    s_mov_b64 exec, s[44:45]
    s_waitcnt lgkmcnt(0)
    ds_read_b128 v[100:103], v4 offset:1024
    ds_read_b128 v[108:111], v4 offset:1536
    s_mov_b64 exec, -1
    ds_read_b128 v[88:91], v3 offset:2048
    v_exp_f32 v18, v18
    v_exp_f32 v19, v19
    v_exp_f32 v20, v20
    v_mfma_f32_32x32x16_bf16 v[32:47], v[92:95], v[84:87], v[64:79]
    v_exp_f32 v21, v21
    v_exp_f32 v22, v22
    v_exp_f32 v23, v23
    v_exp_f32 v24, v24
    v_exp_f32 v25, v25
    v_smfmac_f32_32x32x32_bf16 v[112:127], v[96:99], v[16:23], v2
    s_setprio 1
    v_exp_f32 v26, v26
    v_exp_f32 v27, v27
    v_exp_f32 v28, v28
    v_exp_f32 v29, v29
    v_exp_f32 v30, v30
    v_exp_f32 v31, v31
    v_exp_f32 v32, v32
    v_exp_f32 v33, v33
    v_smfmac_f32_32x32x32_bf16 v[112:127], v[104:107], v[24:31], v2
    s_mov_b64 exec, s[44:45]
    s_waitcnt lgkmcnt(0)
    ds_read_b128 v[96:99], v4 offset:2048
    ds_read_b128 v[104:107], v4 offset:2560
    s_mov_b64 exec, -1
    ds_read_b128 v[92:95], v3 offset:3072
    v_exp_f32 v34, v34
    v_exp_f32 v35, v35
    v_exp_f32 v36, v36
    v_mfma_f32_32x32x16_bf16 v[16:31], v[88:91], v[84:87], v[64:79]
    s_setprio 0
    v_exp_f32 v37, v37
    v_exp_f32 v38, v38
    v_exp_f32 v39, v39
    v_exp_f32 v40, v40
    v_exp_f32 v41, v41
    v_smfmac_f32_32x32x32_bf16 v[112:127], v[100:103], v[32:39], v2
    s_barrier
    v_exp_f32 v42, v42
    v_exp_f32 v43, v43
    v_exp_f32 v44, v44
    v_exp_f32 v45, v45
    v_exp_f32 v46, v46
    v_exp_f32 v47, v47
    v_exp_f32 v16, v16
    v_exp_f32 v17, v17
    v_smfmac_f32_32x32x32_bf16 v[112:127], v[108:111], v[40:47], v2
    s_mov_b64 exec, s[44:45]
    s_waitcnt lgkmcnt(0)
    ds_read_b128 v[100:103], v4 offset:3072
    ds_read_b128 v[108:111], v4 offset:3584
    s_mov_b64 exec, -1
    ds_read_b128 v[88:91], v3 offset:4096
    v_exp_f32 v18, v18
    v_exp_f32 v19, v19
    v_exp_f32 v20, v20
    v_mfma_f32_32x32x16_bf16 v[32:47], v[92:95], v[84:87], v[64:79]
    s_setprio 3
    v_exp_f32 v21, v21
    v_exp_f32 v22, v22
    v_exp_f32 v23, v23
    v_exp_f32 v24, v24
    v_exp_f32 v25, v25
    v_smfmac_f32_32x32x32_bf16 v[112:127], v[96:99], v[16:23], v2
    s_lshl_b32 s51, s3, 12
    s_add_u32 m0, s51, 131072
    s_add_u32 s93, s89, 16384
    buffer_load_dwordx4 v6, s[24:27], s93 offen offset:0 sc1 lds
    v_exp_f32 v26, v26
    v_exp_f32 v27, v27
    v_exp_f32 v28, v28
    v_exp_f32 v29, v29
    v_exp_f32 v30, v30
    v_exp_f32 v31, v31
    v_exp_f32 v32, v32
    v_exp_f32 v33, v33
    v_smfmac_f32_32x32x32_bf16 v[112:127], v[104:107], v[24:31], v2
    s_mov_b64 exec, s[44:45]
    s_waitcnt lgkmcnt(0)
    ds_read_b128 v[96:99], v4 offset:4096
    ds_read_b128 v[104:107], v4 offset:4608
    s_mov_b64 exec, -1
    ds_read_b128 v[92:95], v3 offset:5120
    v_exp_f32 v34, v34
    v_exp_f32 v35, v35
    v_exp_f32 v36, v36
    v_mfma_f32_32x32x16_bf16 v[16:31], v[88:91], v[84:87], v[64:79]
    v_exp_f32 v37, v37
    v_exp_f32 v38, v38
    v_exp_f32 v39, v39
    v_exp_f32 v40, v40
    v_exp_f32 v41, v41
    v_smfmac_f32_32x32x32_bf16 v[112:127], v[100:103], v[32:39], v2
    buffer_load_dwordx4 v6, s[24:27], s93 offen offset:1024 sc1 lds
    v_exp_f32 v42, v42
    v_exp_f32 v43, v43
    v_exp_f32 v44, v44
    v_exp_f32 v45, v45
    v_exp_f32 v46, v46
    v_exp_f32 v47, v47
    v_exp_f32 v16, v16
    v_exp_f32 v17, v17
    v_smfmac_f32_32x32x32_bf16 v[112:127], v[108:111], v[40:47], v2
    s_mov_b64 exec, s[44:45]
    s_waitcnt lgkmcnt(0)
    ds_read_b128 v[100:103], v4 offset:5120
    ds_read_b128 v[108:111], v4 offset:5632
    s_mov_b64 exec, -1
    ds_read_b128 v[88:91], v3 offset:6144
    v_exp_f32 v18, v18
    v_exp_f32 v19, v19
    v_exp_f32 v20, v20
    v_mfma_f32_32x32x16_bf16 v[32:47], v[92:95], v[84:87], v[64:79]
    v_exp_f32 v21, v21
    v_exp_f32 v22, v22
    v_exp_f32 v23, v23
    v_exp_f32 v24, v24
    v_exp_f32 v25, v25
    v_smfmac_f32_32x32x32_bf16 v[112:127], v[96:99], v[16:23], v2
    buffer_load_dwordx4 v6, s[24:27], s93 offen offset:2048 sc1 lds
    v_exp_f32 v26, v26
    v_exp_f32 v27, v27
    v_exp_f32 v28, v28
    v_exp_f32 v29, v29
    v_exp_f32 v30, v30
    v_exp_f32 v31, v31
    v_exp_f32 v32, v32
    v_exp_f32 v33, v33
    v_smfmac_f32_32x32x32_bf16 v[112:127], v[104:107], v[24:31], v2
    s_mov_b64 exec, s[44:45]
    s_waitcnt lgkmcnt(0)
    ds_read_b128 v[96:99], v4 offset:6144
    ds_read_b128 v[104:107], v4 offset:6656
    s_mov_b64 exec, -1
    ds_read_b128 v[92:95], v3 offset:7168
    v_exp_f32 v34, v34
    v_exp_f32 v35, v35
    v_exp_f32 v36, v36
    v_mfma_f32_32x32x16_bf16 v[16:31], v[88:91], v[84:87], v[64:79]
    v_exp_f32 v37, v37
    v_exp_f32 v38, v38
    v_exp_f32 v39, v39
    v_exp_f32 v40, v40
    v_exp_f32 v41, v41
    v_smfmac_f32_32x32x32_bf16 v[112:127], v[100:103], v[32:39], v2
    s_setprio 2
    buffer_load_dwordx4 v6, s[24:27], s93 offen offset:3072 sc1 lds
    v_exp_f32 v42, v42
    v_exp_f32 v43, v43
    v_exp_f32 v44, v44
    v_exp_f32 v45, v45
    v_exp_f32 v46, v46
    v_exp_f32 v47, v47
    v_add_u32 v3, 16384, v3
    v_exp_f32 v16, v16
    v_exp_f32 v17, v17
    v_smfmac_f32_32x32x32_bf16 v[112:127], v[108:111], v[40:47], v2
    s_mov_b64 exec, s[44:45]
    s_waitcnt lgkmcnt(0)
    ds_read_b128 v[100:103], v4 offset:7168
    ds_read_b128 v[108:111], v4 offset:7680
    s_mov_b64 exec, -1
    ds_read_b128 v[88:91], v3 offset:0
    v_exp_f32 v18, v18
    v_exp_f32 v19, v19
    v_exp_f32 v20, v20
    v_mfma_f32_32x32x16_bf16 v[32:47], v[92:95], v[84:87], v[64:79]
    v_exp_f32 v21, v21
    v_exp_f32 v22, v22
    v_exp_f32 v23, v23
    v_exp_f32 v24, v24
    v_exp_f32 v25, v25
    v_smfmac_f32_32x32x32_bf16 v[112:127], v[96:99], v[16:23], v2
    v_exp_f32 v26, v26
    v_exp_f32 v27, v27
    v_exp_f32 v28, v28
    v_exp_f32 v29, v29
    v_exp_f32 v30, v30
    v_exp_f32 v31, v31
    v_add_u32 v4, 16384, v4
    v_exp_f32 v32, v32
    v_exp_f32 v33, v33
    v_smfmac_f32_32x32x32_bf16 v[112:127], v[104:107], v[24:31], v2
    s_mov_b64 exec, s[44:45]
    s_waitcnt lgkmcnt(0)
    ds_read_b128 v[96:99], v4 offset:0
    ds_read_b128 v[104:107], v4 offset:512
    s_mov_b64 exec, -1
    ds_read_b128 v[92:95], v3 offset:1024
    v_exp_f32 v34, v34
    v_exp_f32 v35, v35
    v_exp_f32 v36, v36
    v_mfma_f32_32x32x16_bf16 v[16:31], v[88:91], v[84:87], v[64:79]
    v_exp_f32 v37, v37
    v_exp_f32 v38, v38
    v_exp_f32 v39, v39
    v_exp_f32 v40, v40
    v_exp_f32 v41, v41
    v_smfmac_f32_32x32x32_bf16 v[112:127], v[100:103], v[32:39], v2
    v_exp_f32 v42, v42
    v_exp_f32 v43, v43
    v_exp_f32 v44, v44
    v_exp_f32 v45, v45
    v_exp_f32 v46, v46
    v_exp_f32 v47, v47
    v_exp_f32 v16, v16
    v_exp_f32 v17, v17
    v_smfmac_f32_32x32x32_bf16 v[112:127], v[108:111], v[40:47], v2
    s_mov_b64 exec, s[44:45]
    s_waitcnt lgkmcnt(0)
    ds_read_b128 v[100:103], v4 offset:1024
    ds_read_b128 v[108:111], v4 offset:1536
    s_mov_b64 exec, -1
    ds_read_b128 v[88:91], v3 offset:2048
    v_exp_f32 v18, v18
    v_exp_f32 v19, v19
    v_exp_f32 v20, v20
    v_mfma_f32_32x32x16_bf16 v[32:47], v[92:95], v[84:87], v[64:79]
    v_exp_f32 v21, v21
    v_exp_f32 v22, v22
    v_exp_f32 v23, v23
    v_exp_f32 v24, v24
    v_exp_f32 v25, v25
    v_smfmac_f32_32x32x32_bf16 v[112:127], v[96:99], v[16:23], v2
    s_setprio 1
    v_exp_f32 v26, v26
    v_exp_f32 v27, v27
    v_exp_f32 v28, v28
    v_exp_f32 v29, v29
    v_exp_f32 v30, v30
    v_exp_f32 v31, v31
    v_exp_f32 v32, v32
    v_exp_f32 v33, v33
    v_smfmac_f32_32x32x32_bf16 v[112:127], v[104:107], v[24:31], v2
    s_mov_b64 exec, s[44:45]
    s_waitcnt lgkmcnt(0)
    ds_read_b128 v[96:99], v4 offset:2048
    ds_read_b128 v[104:107], v4 offset:2560
    s_mov_b64 exec, -1
    ds_read_b128 v[92:95], v3 offset:3072
    v_exp_f32 v34, v34
    v_exp_f32 v35, v35
    v_exp_f32 v36, v36
    v_mfma_f32_32x32x16_bf16 v[16:31], v[88:91], v[84:87], v[64:79]
    s_setprio 0
    v_exp_f32 v37, v37
    v_exp_f32 v38, v38
    v_exp_f32 v39, v39
    v_exp_f32 v40, v40
    v_exp_f32 v41, v41
    v_smfmac_f32_32x32x32_bf16 v[112:127], v[100:103], v[32:39], v2
    s_barrier
    v_exp_f32 v42, v42
    v_exp_f32 v43, v43
    v_exp_f32 v44, v44
    v_exp_f32 v45, v45
    v_exp_f32 v46, v46
    v_exp_f32 v47, v47
    v_exp_f32 v16, v16
    v_exp_f32 v17, v17
    v_smfmac_f32_32x32x32_bf16 v[112:127], v[108:111], v[40:47], v2
    s_mov_b64 exec, s[44:45]
    s_waitcnt lgkmcnt(0)
    ds_read_b128 v[100:103], v4 offset:3072
    ds_read_b128 v[108:111], v4 offset:3584
    s_mov_b64 exec, -1
    ds_read_b128 v[88:91], v3 offset:4096
    v_exp_f32 v18, v18
    v_exp_f32 v19, v19
    v_exp_f32 v20, v20
    v_mfma_f32_32x32x16_bf16 v[32:47], v[92:95], v[84:87], v[64:79]
    s_setprio 3
    v_exp_f32 v21, v21
    v_exp_f32 v22, v22
    v_exp_f32 v23, v23
    v_exp_f32 v24, v24
    v_exp_f32 v25, v25
    v_smfmac_f32_32x32x32_bf16 v[112:127], v[96:99], v[16:23], v2
    s_lshl_b32 s51, s3, 12
    s_add_u32 m0, s51, 0
    s_add_u32 s93, s89, 32768
    buffer_load_dwordx4 v6, s[24:27], s93 offen offset:0 sc1 lds
    v_exp_f32 v26, v26
    v_exp_f32 v27, v27
    v_exp_f32 v28, v28
    v_exp_f32 v29, v29
    v_exp_f32 v30, v30
    v_exp_f32 v31, v31
    v_exp_f32 v32, v32
    v_exp_f32 v33, v33
    v_smfmac_f32_32x32x32_bf16 v[112:127], v[104:107], v[24:31], v2
    s_mov_b64 exec, s[44:45]
    s_waitcnt lgkmcnt(0)
    ds_read_b128 v[96:99], v4 offset:4096
    ds_read_b128 v[104:107], v4 offset:4608
    s_mov_b64 exec, -1
    ds_read_b128 v[92:95], v3 offset:5120
    v_exp_f32 v34, v34
    v_exp_f32 v35, v35
    v_exp_f32 v36, v36
    v_mfma_f32_32x32x16_bf16 v[16:31], v[88:91], v[84:87], v[64:79]
    v_exp_f32 v37, v37
    v_exp_f32 v38, v38
    v_exp_f32 v39, v39
    v_exp_f32 v40, v40
    v_exp_f32 v41, v41
    v_smfmac_f32_32x32x32_bf16 v[112:127], v[100:103], v[32:39], v2
    buffer_load_dwordx4 v6, s[24:27], s93 offen offset:1024 sc1 lds
    v_exp_f32 v42, v42
    v_exp_f32 v43, v43
    v_exp_f32 v44, v44
    v_exp_f32 v45, v45
    v_exp_f32 v46, v46
    v_exp_f32 v47, v47
    v_exp_f32 v16, v16
    v_exp_f32 v17, v17
    v_smfmac_f32_32x32x32_bf16 v[112:127], v[108:111], v[40:47], v2
    s_mov_b64 exec, s[44:45]
    s_waitcnt lgkmcnt(0)
    ds_read_b128 v[100:103], v4 offset:5120
    ds_read_b128 v[108:111], v4 offset:5632
    s_mov_b64 exec, -1
    ds_read_b128 v[88:91], v3 offset:6144
    v_exp_f32 v18, v18
    v_exp_f32 v19, v19
    v_exp_f32 v20, v20
    v_mfma_f32_32x32x16_bf16 v[32:47], v[92:95], v[84:87], v[64:79]
    v_exp_f32 v21, v21
    v_exp_f32 v22, v22
    v_exp_f32 v23, v23
    v_exp_f32 v24, v24
    v_exp_f32 v25, v25
    v_smfmac_f32_32x32x32_bf16 v[112:127], v[96:99], v[16:23], v2
    buffer_load_dwordx4 v6, s[24:27], s93 offen offset:2048 sc1 lds
    v_exp_f32 v26, v26
    v_exp_f32 v27, v27
    v_exp_f32 v28, v28
    v_exp_f32 v29, v29
    v_exp_f32 v30, v30
    v_exp_f32 v31, v31
    v_exp_f32 v32, v32
    v_exp_f32 v33, v33
    v_smfmac_f32_32x32x32_bf16 v[112:127], v[104:107], v[24:31], v2
    s_mov_b64 exec, s[44:45]
    s_waitcnt lgkmcnt(0)
    ds_read_b128 v[96:99], v4 offset:6144
    ds_read_b128 v[104:107], v4 offset:6656
    s_mov_b64 exec, -1
    ds_read_b128 v[92:95], v3 offset:7168
    v_exp_f32 v34, v34
    v_exp_f32 v35, v35
    v_exp_f32 v36, v36
    v_mfma_f32_32x32x16_bf16 v[16:31], v[88:91], v[84:87], v[64:79]
    v_exp_f32 v37, v37
    v_exp_f32 v38, v38
    v_exp_f32 v39, v39
    v_exp_f32 v40, v40
    v_exp_f32 v41, v41
    v_smfmac_f32_32x32x32_bf16 v[112:127], v[100:103], v[32:39], v2
    s_setprio 2
    buffer_load_dwordx4 v6, s[24:27], s93 offen offset:3072 sc1 lds
    v_exp_f32 v42, v42
    v_exp_f32 v43, v43
    v_exp_f32 v44, v44
    v_exp_f32 v45, v45
    v_exp_f32 v46, v46
    v_exp_f32 v47, v47
    v_add_u32 v3, 16384, v3
    v_exp_f32 v16, v16
    v_exp_f32 v17, v17
    v_smfmac_f32_32x32x32_bf16 v[112:127], v[108:111], v[40:47], v2
    s_mov_b64 exec, s[44:45]
    s_waitcnt lgkmcnt(0)
    ds_read_b128 v[100:103], v4 offset:7168
    ds_read_b128 v[108:111], v4 offset:7680
    s_mov_b64 exec, -1
    ds_read_b128 v[88:91], v3 offset:0
    v_exp_f32 v18, v18
    v_exp_f32 v19, v19
    v_exp_f32 v20, v20
    v_mfma_f32_32x32x16_bf16 v[32:47], v[92:95], v[84:87], v[64:79]
    v_exp_f32 v21, v21
    v_exp_f32 v22, v22
    v_exp_f32 v23, v23
    v_exp_f32 v24, v24
    v_exp_f32 v25, v25
    v_smfmac_f32_32x32x32_bf16 v[112:127], v[96:99], v[16:23], v2
    v_exp_f32 v26, v26
    v_exp_f32 v27, v27
    v_exp_f32 v28, v28
    v_exp_f32 v29, v29
    v_exp_f32 v30, v30
    v_exp_f32 v31, v31
    v_add_u32 v4, 16384, v4
    v_exp_f32 v32, v32
    v_exp_f32 v33, v33
    v_smfmac_f32_32x32x32_bf16 v[112:127], v[104:107], v[24:31], v2
    s_mov_b64 exec, s[44:45]
    s_waitcnt lgkmcnt(0)
    ds_read_b128 v[96:99], v4 offset:0
    ds_read_b128 v[104:107], v4 offset:512
    s_mov_b64 exec, -1
    ds_read_b128 v[92:95], v3 offset:1024
    v_exp_f32 v34, v34
    v_exp_f32 v35, v35
    v_exp_f32 v36, v36
    v_mfma_f32_32x32x16_bf16 v[16:31], v[88:91], v[84:87], v[64:79]
    v_exp_f32 v37, v37
    v_exp_f32 v38, v38
    v_exp_f32 v39, v39
    v_exp_f32 v40, v40
    v_exp_f32 v41, v41
    v_smfmac_f32_32x32x32_bf16 v[112:127], v[100:103], v[32:39], v2
    v_exp_f32 v42, v42
    v_exp_f32 v43, v43
    v_exp_f32 v44, v44
    v_exp_f32 v45, v45
    v_exp_f32 v46, v46
    v_exp_f32 v47, v47
    v_exp_f32 v16, v16
    v_exp_f32 v17, v17
    v_smfmac_f32_32x32x32_bf16 v[112:127], v[108:111], v[40:47], v2
    s_mov_b64 exec, s[44:45]
    s_waitcnt lgkmcnt(0)
    ds_read_b128 v[100:103], v4 offset:1024
    ds_read_b128 v[108:111], v4 offset:1536
    s_mov_b64 exec, -1
    ds_read_b128 v[88:91], v3 offset:2048
    v_exp_f32 v18, v18
    v_exp_f32 v19, v19
    v_exp_f32 v20, v20
    v_mfma_f32_32x32x16_bf16 v[32:47], v[92:95], v[84:87], v[64:79]
    v_exp_f32 v21, v21
    v_exp_f32 v22, v22
    v_exp_f32 v23, v23
    v_exp_f32 v24, v24
    v_exp_f32 v25, v25
    v_smfmac_f32_32x32x32_bf16 v[112:127], v[96:99], v[16:23], v2
    s_setprio 1
    v_exp_f32 v26, v26
    v_exp_f32 v27, v27
    v_exp_f32 v28, v28
    v_exp_f32 v29, v29
    v_exp_f32 v30, v30
    v_exp_f32 v31, v31
    v_exp_f32 v32, v32
    v_exp_f32 v33, v33
    v_smfmac_f32_32x32x32_bf16 v[112:127], v[104:107], v[24:31], v2
    s_mov_b64 exec, s[44:45]
    s_waitcnt lgkmcnt(0)
    ds_read_b128 v[96:99], v4 offset:2048
    ds_read_b128 v[104:107], v4 offset:2560
    s_mov_b64 exec, -1
    ds_read_b128 v[92:95], v3 offset:3072
    v_exp_f32 v34, v34
    v_exp_f32 v35, v35
    v_exp_f32 v36, v36
    v_mfma_f32_32x32x16_bf16 v[16:31], v[88:91], v[84:87], v[64:79]
    s_setprio 0
    v_exp_f32 v37, v37
    v_exp_f32 v38, v38
    v_exp_f32 v39, v39
    v_exp_f32 v40, v40
    v_exp_f32 v41, v41
    v_smfmac_f32_32x32x32_bf16 v[112:127], v[100:103], v[32:39], v2
    s_waitcnt vmcnt(8)
    s_barrier
    v_exp_f32 v42, v42
    v_exp_f32 v43, v43
    v_exp_f32 v44, v44
    v_exp_f32 v45, v45
    v_exp_f32 v46, v46
    v_exp_f32 v47, v47
    v_exp_f32 v16, v16
    v_exp_f32 v17, v17
    v_smfmac_f32_32x32x32_bf16 v[112:127], v[108:111], v[40:47], v2
    s_mov_b64 exec, s[44:45]
    s_waitcnt lgkmcnt(0)
    ds_read_b128 v[100:103], v4 offset:3072
    ds_read_b128 v[108:111], v4 offset:3584
    s_mov_b64 exec, -1
    ds_read_b128 v[88:91], v3 offset:4096
    v_exp_f32 v18, v18
    v_exp_f32 v19, v19
    v_exp_f32 v20, v20
    v_mfma_f32_32x32x16_bf16 v[32:47], v[92:95], v[84:87], v[64:79]
    s_setprio 3
    v_exp_f32 v21, v21
    v_exp_f32 v22, v22
    v_exp_f32 v23, v23
    v_exp_f32 v24, v24
    v_exp_f32 v25, v25
    v_smfmac_f32_32x32x32_bf16 v[112:127], v[96:99], v[16:23], v2
    s_lshl_b32 s51, s3, 12
    s_add_u32 m0, s51, 32768
    s_add_u32 s93, s89, 49152
    buffer_load_dwordx4 v6, s[24:27], s93 offen offset:0 sc1 lds
    v_exp_f32 v26, v26
    v_exp_f32 v27, v27
    v_exp_f32 v28, v28
    v_exp_f32 v29, v29
    v_exp_f32 v30, v30
    v_exp_f32 v31, v31
    s_lshl_b32 s50, s7, 14
    s_add_u32 s50, s50, 16384
    v_add_u32 v11, s50, v3
    v_exp_f32 v32, v32
    v_exp_f32 v33, v33
    v_smfmac_f32_32x32x32_bf16 v[112:127], v[104:107], v[24:31], v2
    s_mov_b64 exec, s[44:45]
    s_waitcnt lgkmcnt(0)
    ds_read_b128 v[96:99], v4 offset:4096
    ds_read_b128 v[104:107], v4 offset:4608
    s_mov_b64 exec, -1
    ds_read_b128 v[92:95], v3 offset:5120
    ds_read_b128 v[192:195], v11 offset:0
    ds_read_b128 v[196:199], v11 offset:1024
    v_exp_f32 v34, v34
    v_exp_f32 v35, v35
    v_exp_f32 v36, v36
    v_mfma_f32_32x32x16_bf16 v[16:31], v[88:91], v[84:87], v[64:79]
    v_exp_f32 v37, v37
    v_exp_f32 v38, v38
    v_exp_f32 v39, v39
    v_exp_f32 v40, v40
    v_exp_f32 v41, v41
    v_smfmac_f32_32x32x32_bf16 v[112:127], v[100:103], v[32:39], v2
    buffer_load_dwordx4 v6, s[24:27], s93 offen offset:1024 sc1 lds
    v_exp_f32 v42, v42
    v_exp_f32 v43, v43
    v_exp_f32 v44, v44
    v_exp_f32 v45, v45
    v_exp_f32 v46, v46
    v_exp_f32 v47, v47
    v_exp_f32 v16, v16
    v_exp_f32 v17, v17
    v_smfmac_f32_32x32x32_bf16 v[112:127], v[108:111], v[40:47], v2
    s_mov_b64 exec, s[44:45]
    s_waitcnt lgkmcnt(0)
    ds_read_b128 v[100:103], v4 offset:5120
    ds_read_b128 v[108:111], v4 offset:5632
    s_mov_b64 exec, -1
    ds_read_b128 v[88:91], v3 offset:6144
    v_exp_f32 v18, v18
    v_exp_f32 v19, v19
    v_exp_f32 v20, v20
    v_mfma_f32_32x32x16_bf16 v[32:47], v[92:95], v[84:87], v[64:79]
    v_exp_f32 v21, v21
    v_exp_f32 v22, v22
    v_mfma_f32_32x32x16_bf16 v[128:143], v[192:195], v[80:83], 0
    v_exp_f32 v23, v23
    v_exp_f32 v24, v24
    v_exp_f32 v25, v25
    v_smfmac_f32_32x32x32_bf16 v[112:127], v[96:99], v[16:23], v2
    buffer_load_dwordx4 v6, s[24:27], s93 offen offset:2048 sc1 lds
    v_exp_f32 v26, v26
    v_exp_f32 v27, v27
    v_exp_f32 v28, v28
    v_mfma_f32_32x32x16_bf16 v[144:159], v[196:199], v[80:83], 0
    v_exp_f32 v29, v29
    v_exp_f32 v30, v30
    v_exp_f32 v31, v31
    v_exp_f32 v32, v32
    v_exp_f32 v33, v33
    v_smfmac_f32_32x32x32_bf16 v[112:127], v[104:107], v[24:31], v2
    s_mov_b64 exec, s[44:45]
    s_waitcnt lgkmcnt(0)
    ds_read_b128 v[96:99], v4 offset:6144
    ds_read_b128 v[104:107], v4 offset:6656
    s_mov_b64 exec, -1
    ds_read_b128 v[92:95], v3 offset:7168
    v_exp_f32 v34, v34
    v_exp_f32 v35, v35
    v_exp_f32 v36, v36
    v_mfma_f32_32x32x16_bf16 v[16:31], v[88:91], v[84:87], v[64:79]
    v_exp_f32 v37, v37
    v_max3_f32 v8, v128, v129, v130
    v_max3_f32 v9, v131, v132, v133
    v_max3_f32 v8, v8, v134, v135
    v_max3_f32 v9, v9, v136, v137
    v_max3_f32 v8, v8, v138, v139
    v_max3_f32 v9, v9, v140, v141
    v_max3_f32 v8, v8, v142, v143
    v_max3_f32 v9, v9, v144, v145
    v_exp_f32 v38, v38
    v_exp_f32 v39, v39
    v_exp_f32 v40, v40
    v_exp_f32 v41, v41
    v_smfmac_f32_32x32x32_bf16 v[112:127], v[100:103], v[32:39], v2
    s_setprio 2
    buffer_load_dwordx4 v6, s[24:27], s93 offen offset:3072 sc1 lds
    v_exp_f32 v42, v42
    v_exp_f32 v43, v43
    v_exp_f32 v44, v44
    v_exp_f32 v45, v45
    v_exp_f32 v46, v46
    v_exp_f32 v47, v47
    s_lshl_b32 s50, s7, 14
    s_add_u32 s50, s50, 16384
    v_add_u32 v3, s50, v3
    v_exp_f32 v16, v16
    v_exp_f32 v17, v17
    v_smfmac_f32_32x32x32_bf16 v[112:127], v[108:111], v[40:47], v2
    s_mov_b64 exec, s[44:45]
    s_waitcnt lgkmcnt(0)
    ds_read_b128 v[100:103], v4 offset:7168
    ds_read_b128 v[108:111], v4 offset:7680
    s_mov_b64 exec, -1
    ds_read_b128 v[88:91], v3 offset:0
    v_exp_f32 v18, v18
    v_exp_f32 v19, v19
    v_exp_f32 v20, v20
    v_mfma_f32_32x32x16_bf16 v[32:47], v[92:95], v[84:87], v[64:79]
    v_exp_f32 v21, v21
    v_max3_f32 v8, v8, v146, v147
    v_max3_f32 v9, v9, v148, v149
    v_max3_f32 v8, v8, v150, v151
    v_max3_f32 v9, v9, v152, v153
    v_max3_f32 v8, v8, v154, v155
    v_max3_f32 v9, v9, v156, v157
    v_max3_f32 v8, v8, v158, v159
    v_max_f32 v8, v8, v9
    v_mov_b32 v9, v8
    v_exp_f32 v22, v22
    v_exp_f32 v23, v23
    v_permlane32_swap_b32 v8, v9
    v_exp_f32 v24, v24
    v_exp_f32 v25, v25
    v_smfmac_f32_32x32x32_bf16 v[112:127], v[96:99], v[16:23], v2
    v_exp_f32 v26, v26
    v_exp_f32 v27, v27
    v_max_f32 v8, v8, v9
    v_sub_f32 v64, 0xc2cc0000, v8
    v_sub_f32 v65, 0xc2cc0000, v8
    v_mov_b64 v[66:67], v[64:65]
    v_mov_b64 v[68:69], v[64:65]
    v_mov_b64 v[70:71], v[64:65]
    v_mov_b64 v[72:73], v[64:65]
    v_mov_b64 v[74:75], v[64:65]
    v_mov_b64 v[76:77], v[64:65]
    v_mov_b64 v[78:79], v[64:65]
    v_exp_f32 v28, v28
    v_exp_f32 v29, v29
    v_exp_f32 v30, v30
    v_exp_f32 v31, v31
    s_lshl_b32 s50, s7, 14
    s_add_u32 s50, s50, 16384
    v_add_u32 v4, s50, v4
    v_exp_f32 v32, v32
    v_exp_f32 v33, v33
    v_smfmac_f32_32x32x32_bf16 v[112:127], v[104:107], v[24:31], v2
    s_mov_b64 exec, s[44:45]
    s_waitcnt lgkmcnt(0)
    ds_read_b128 v[96:99], v4 offset:0
    ds_read_b128 v[104:107], v4 offset:512
    s_mov_b64 exec, -1
    ds_read_b128 v[92:95], v3 offset:1024
    v_exp_f32 v34, v34
    v_exp_f32 v35, v35
    v_exp_f32 v36, v36
    v_mfma_f32_32x32x16_bf16 v[16:31], v[88:91], v[80:83], v[64:79]
    v_exp_f32 v37, v37
    v_exp_f32 v38, v38
    v_exp_f32 v39, v39
    v_exp_f32 v40, v40
    v_exp_f32 v41, v41
    v_smfmac_f32_32x32x32_bf16 v[112:127], v[100:103], v[32:39], v2
    v_exp_f32 v42, v42
    v_exp_f32 v43, v43
    v_exp_f32 v44, v44
    v_exp_f32 v45, v45
    v_exp_f32 v46, v46
    v_exp_f32 v47, v47
    v_exp_f32 v16, v16
    v_exp_f32 v17, v17
    v_smfmac_f32_32x32x32_bf16 v[112:127], v[108:111], v[40:47], v2
    s_mov_b64 exec, s[44:45]
    s_waitcnt lgkmcnt(0)
    ds_read_b128 v[100:103], v4 offset:1024
    ds_read_b128 v[108:111], v4 offset:1536
    s_mov_b64 exec, -1
    ds_read_b128 v[88:91], v3 offset:2048
    v_exp_f32 v18, v18
    v_exp_f32 v19, v19
    v_exp_f32 v20, v20
    v_mfma_f32_32x32x16_bf16 v[32:47], v[92:95], v[80:83], v[64:79]
    v_exp_f32 v21, v21
    v_exp_f32 v22, v22
    v_exp_f32 v23, v23
    v_exp_f32 v24, v24
    v_exp_f32 v25, v25
    v_smfmac_f32_32x32x32_bf16 v[48:63], v[96:99], v[16:23], v2
    s_setprio 1
    v_exp_f32 v26, v26
    v_exp_f32 v27, v27
    v_exp_f32 v28, v28
    v_exp_f32 v29, v29
    v_exp_f32 v30, v30
    v_exp_f32 v31, v31
    v_mov_b32 v8, v120
    v_add_f32 v10, |v112|, |v113|
    v_add_f32 v10, v10, |v114|
    v_add_f32 v10, v10, |v115|
    v_add_f32 v10, v10, |v116|
    v_add_f32 v10, v10, |v117|
    v_add_f32 v10, v10, |v118|
    v_add_f32 v10, v10, |v119|
    v_permlane32_swap_b32 v8, v120
    v_subrev_u32 v10, 142606336, v10
    s_mov_b32 s50, 1929379840
    v_exp_f32 v32, v32
    v_subrev_u32 v11, 142606336, v8
    v_max_u32 v10, v10, v11
    v_cmp_le_u32 vcc, s50, v10
    s_nop 0
    s_cbranch_vccnz L_fallback0
L_fbret0:
    v_rcp_f32 v8, v8
    v_sub_f32 v11, 1.0, v5
    v_exp_f32 v33, v33
    v_smfmac_f32_32x32x32_bf16 v[48:63], v[104:107], v[24:31], v2
    s_mov_b64 exec, s[44:45]
    s_waitcnt lgkmcnt(0)
    ds_read_b128 v[96:99], v4 offset:2048
    ds_read_b128 v[104:107], v4 offset:2560
    s_mov_b64 exec, -1
    ds_read_b128 v[92:95], v3 offset:3072
    v_exp_f32 v34, v34
    v_exp_f32 v35, v35
    v_exp_f32 v36, v36
    v_mfma_f32_32x32x16_bf16 v[16:31], v[88:91], v[80:83], v[64:79]
    s_setprio 0
    v_exp_f32 v37, v37
    v_mul_f32 v8, v8, v11
    v_pk_mul_f32 v[112:113], v[112:113], v[8:9] op_sel_hi:[1,0]
    v_pk_mul_f32 v[114:115], v[114:115], v[8:9] op_sel_hi:[1,0]
    v_pk_mul_f32 v[116:117], v[116:117], v[8:9] op_sel_hi:[1,0]
    v_pk_mul_f32 v[118:119], v[118:119], v[8:9] op_sel_hi:[1,0]
    v_cvt_pk_bf16_f32 v12, v112, v113
    v_cvt_pk_bf16_f32 v13, v114, v115
    v_cvt_pk_bf16_f32 v14, v116, v117
    v_cvt_pk_bf16_f32 v15, v118, v119
    s_add_u32 s50, s90, 5242880
    buffer_store_dwordx4 v[12:15], v6, s[24:27], s50 offen sc1
    v_exp_f32 v38, v38
    v_exp_f32 v39, v39
    v_exp_f32 v40, v40
    v_exp_f32 v41, v41
    v_smfmac_f32_32x32x32_bf16 v[48:63], v[100:103], v[32:39], v2
    s_waitcnt vmcnt(9)
    s_barrier
    v_exp_f32 v42, v42
    v_exp_f32 v43, v43
    v_exp_f32 v44, v44
    v_exp_f32 v45, v45
    v_exp_f32 v46, v46
    v_exp_f32 v47, v47
    v_exp_f32 v16, v16
    v_exp_f32 v17, v17
    v_smfmac_f32_32x32x32_bf16 v[48:63], v[108:111], v[40:47], v2
    s_mov_b64 exec, s[44:45]
    s_waitcnt lgkmcnt(0)
    ds_read_b128 v[100:103], v4 offset:3072
    ds_read_b128 v[108:111], v4 offset:3584
    s_mov_b64 exec, -1
    ds_read_b128 v[88:91], v3 offset:4096
    v_exp_f32 v18, v18
    v_exp_f32 v19, v19
    v_exp_f32 v20, v20
    v_mfma_f32_32x32x16_bf16 v[32:47], v[92:95], v[80:83], v[64:79]
    s_setprio 3
    v_exp_f32 v21, v21
    v_exp_f32 v22, v22
    v_exp_f32 v23, v23
    v_exp_f32 v24, v24
    v_exp_f32 v25, v25
    v_smfmac_f32_32x32x32_bf16 v[48:63], v[96:99], v[16:23], v2
    s_lshl_b32 s51, s3, 12
    s_add_u32 m0, s51, 65536
    s_add_u32 s93, s89, 65536
    buffer_load_dwordx4 v6, s[24:27], s93 offen offset:0 sc1 lds
    v_exp_f32 v26, v26
    v_exp_f32 v27, v27
    v_exp_f32 v28, v28
    v_exp_f32 v29, v29
    v_exp_f32 v30, v30
    v_exp_f32 v31, v31
    v_exp_f32 v32, v32
    v_exp_f32 v33, v33
    v_smfmac_f32_32x32x32_bf16 v[48:63], v[104:107], v[24:31], v2
    s_mov_b64 exec, s[44:45]
    s_waitcnt lgkmcnt(0)
    ds_read_b128 v[96:99], v4 offset:4096
    ds_read_b128 v[104:107], v4 offset:4608
    s_mov_b64 exec, -1
    ds_read_b128 v[92:95], v3 offset:5120
    v_exp_f32 v34, v34
    v_exp_f32 v35, v35
    v_exp_f32 v36, v36
    v_mfma_f32_32x32x16_bf16 v[16:31], v[88:91], v[80:83], v[64:79]
    v_exp_f32 v37, v37
    v_exp_f32 v38, v38
    v_exp_f32 v39, v39
    v_exp_f32 v40, v40
    v_exp_f32 v41, v41
    v_smfmac_f32_32x32x32_bf16 v[48:63], v[100:103], v[32:39], v2
    buffer_load_dwordx4 v6, s[24:27], s93 offen offset:1024 sc1 lds
    v_exp_f32 v42, v42
    v_exp_f32 v43, v43
    v_exp_f32 v44, v44
    v_exp_f32 v45, v45
    v_exp_f32 v46, v46
    v_exp_f32 v47, v47
    v_exp_f32 v16, v16
    v_exp_f32 v17, v17
    v_smfmac_f32_32x32x32_bf16 v[48:63], v[108:111], v[40:47], v2
    s_mov_b64 exec, s[44:45]
    s_waitcnt lgkmcnt(0)
    ds_read_b128 v[100:103], v4 offset:5120
    ds_read_b128 v[108:111], v4 offset:5632
    s_mov_b64 exec, -1
    ds_read_b128 v[88:91], v3 offset:6144
    v_exp_f32 v18, v18
    v_exp_f32 v19, v19
    v_exp_f32 v20, v20
    v_mfma_f32_32x32x16_bf16 v[32:47], v[92:95], v[80:83], v[64:79]
    v_exp_f32 v21, v21
    v_exp_f32 v22, v22
    v_exp_f32 v23, v23
    v_exp_f32 v24, v24
    v_exp_f32 v25, v25
    v_smfmac_f32_32x32x32_bf16 v[48:63], v[96:99], v[16:23], v2
    buffer_load_dwordx4 v6, s[24:27], s93 offen offset:2048 sc1 lds
    v_exp_f32 v26, v26
    v_exp_f32 v27, v27
    v_exp_f32 v28, v28
    v_exp_f32 v29, v29
    v_exp_f32 v30, v30
    v_exp_f32 v31, v31
    v_exp_f32 v32, v32
    v_exp_f32 v33, v33
    v_smfmac_f32_32x32x32_bf16 v[48:63], v[104:107], v[24:31], v2
    s_mov_b64 exec, s[44:45]
    s_waitcnt lgkmcnt(0)
    ds_read_b128 v[96:99], v4 offset:6144
    ds_read_b128 v[104:107], v4 offset:6656
    s_mov_b64 exec, -1
    ds_read_b128 v[92:95], v3 offset:7168
    v_exp_f32 v34, v34
    v_exp_f32 v35, v35
    v_exp_f32 v36, v36
    v_mfma_f32_32x32x16_bf16 v[16:31], v[88:91], v[80:83], v[64:79]
    v_exp_f32 v37, v37
    v_exp_f32 v38, v38
    v_exp_f32 v39, v39
    v_exp_f32 v40, v40
    v_exp_f32 v41, v41
    v_smfmac_f32_32x32x32_bf16 v[48:63], v[100:103], v[32:39], v2
    s_setprio 2
    buffer_load_dwordx4 v6, s[24:27], s93 offen offset:3072 sc1 lds
    v_exp_f32 v42, v42
    v_exp_f32 v43, v43
    v_exp_f32 v44, v44
    v_exp_f32 v45, v45
    v_exp_f32 v46, v46
    v_exp_f32 v47, v47
    v_add_u32 v3, 32768, v3
    v_exp_f32 v16, v16
    v_exp_f32 v17, v17
    v_smfmac_f32_32x32x32_bf16 v[48:63], v[108:111], v[40:47], v2
    s_mov_b64 exec, s[44:45]
    s_waitcnt lgkmcnt(0)
    ds_read_b128 v[100:103], v4 offset:7168
    ds_read_b128 v[108:111], v4 offset:7680
    s_mov_b64 exec, -1
    ds_read_b128 v[88:91], v3 offset:0
    v_exp_f32 v18, v18
    v_exp_f32 v19, v19
    v_exp_f32 v20, v20
    v_mfma_f32_32x32x16_bf16 v[32:47], v[92:95], v[80:83], v[64:79]
    v_exp_f32 v21, v21
    v_exp_f32 v22, v22
    v_exp_f32 v23, v23
    v_exp_f32 v24, v24
    v_exp_f32 v25, v25
    v_smfmac_f32_32x32x32_bf16 v[48:63], v[96:99], v[16:23], v2
    v_exp_f32 v26, v26
    v_exp_f32 v27, v27
    v_exp_f32 v28, v28
    v_exp_f32 v29, v29
    v_exp_f32 v30, v30
    v_exp_f32 v31, v31
    v_add_u32 v4, 32768, v4
    v_exp_f32 v32, v32
    v_exp_f32 v33, v33
    v_smfmac_f32_32x32x32_bf16 v[48:63], v[104:107], v[24:31], v2
    s_mov_b64 exec, s[44:45]
    s_waitcnt lgkmcnt(0)
    ds_read_b128 v[96:99], v4 offset:0
    ds_read_b128 v[104:107], v4 offset:512
    s_mov_b64 exec, -1
    ds_read_b128 v[92:95], v3 offset:1024
    v_exp_f32 v34, v34
    v_exp_f32 v35, v35
    v_exp_f32 v36, v36
    v_mfma_f32_32x32x16_bf16 v[16:31], v[88:91], v[80:83], v[64:79]
    v_exp_f32 v37, v37
    v_exp_f32 v38, v38
    v_exp_f32 v39, v39
    v_exp_f32 v40, v40
    v_exp_f32 v41, v41
    v_smfmac_f32_32x32x32_bf16 v[48:63], v[100:103], v[32:39], v2
    v_exp_f32 v42, v42
    v_exp_f32 v43, v43
    v_exp_f32 v44, v44
    v_exp_f32 v45, v45
    v_exp_f32 v46, v46
    v_exp_f32 v47, v47
    v_exp_f32 v16, v16
    v_exp_f32 v17, v17
    v_smfmac_f32_32x32x32_bf16 v[48:63], v[108:111], v[40:47], v2
    s_mov_b64 exec, s[44:45]
    s_waitcnt lgkmcnt(0)
    ds_read_b128 v[100:103], v4 offset:1024
    ds_read_b128 v[108:111], v4 offset:1536
    s_mov_b64 exec, -1
    ds_read_b128 v[88:91], v3 offset:2048
    v_exp_f32 v18, v18
    v_exp_f32 v19, v19
    v_exp_f32 v20, v20
    v_mfma_f32_32x32x16_bf16 v[32:47], v[92:95], v[80:83], v[64:79]
    v_exp_f32 v21, v21
    v_exp_f32 v22, v22
    v_exp_f32 v23, v23
    v_exp_f32 v24, v24
    v_mov_b32 v8, v56
    v_mov_b32 v9, v56
    v_exp_f32 v25, v25
    v_smfmac_f32_32x32x32_bf16 v[48:63], v[96:99], v[16:23], v2
    s_setprio 1
    v_exp_f32 v26, v26
    v_permlane32_swap_b32 v8, v9
    v_exp_f32 v27, v27
    v_frexp_exp_i32_f32 v8, v8
    v_add_u32 v8, 101, v8
    v_min_i32 v8, 0x78, v8
    v_cvt_f32_i32 v9, v8
    v_sub_u32 v8, 0, v8
    v_ldexp_f32 v10, 1.0, v8
    v_exp_f32 v28, v28
    v_sub_f32 v64, v64, v9
    v_sub_f32 v65, v65, v9
    v_mov_b64 v[66:67], v[64:65]
    v_mov_b64 v[68:69], v[64:65]
    v_mov_b64 v[70:71], v[64:65]
    v_mov_b64 v[72:73], v[64:65]
    v_mov_b64 v[74:75], v[64:65]
    v_mov_b64 v[76:77], v[64:65]
    v_mov_b64 v[78:79], v[64:65]
    v_exp_f32 v29, v29
    v_exp_f32 v30, v30
    v_exp_f32 v31, v31
    v_exp_f32 v32, v32
    v_exp_f32 v33, v33
    v_smfmac_f32_32x32x32_bf16 v[48:63], v[104:107], v[24:31], v2
    s_mov_b64 exec, s[44:45]
    s_waitcnt lgkmcnt(0)
    ds_read_b128 v[96:99], v4 offset:2048
    ds_read_b128 v[104:107], v4 offset:2560
    s_mov_b64 exec, -1
    ds_read_b128 v[92:95], v3 offset:3072
    v_exp_f32 v34, v34
    v_exp_f32 v35, v35
    v_exp_f32 v36, v36
    v_mfma_f32_32x32x16_bf16 v[16:31], v[88:91], v[80:83], v[64:79]
    s_setprio 0
    v_exp_f32 v37, v37
    v_exp_f32 v38, v38
    v_exp_f32 v39, v39
    v_exp_f32 v40, v40
    v_exp_f32 v41, v41
    v_smfmac_f32_32x32x32_bf16 v[48:63], v[100:103], v[32:39], v2
    s_waitcnt vmcnt(9)
    s_barrier
    v_exp_f32 v42, v42
    v_exp_f32 v43, v43
    v_exp_f32 v44, v44
    v_exp_f32 v45, v45
    v_exp_f32 v46, v46
    v_exp_f32 v47, v47
    v_exp_f32 v16, v16
    v_exp_f32 v17, v17
    v_smfmac_f32_32x32x32_bf16 v[48:63], v[108:111], v[40:47], v2
    s_mov_b64 exec, s[44:45]
    s_waitcnt lgkmcnt(0)
    ds_read_b128 v[100:103], v4 offset:3072
    ds_read_b128 v[108:111], v4 offset:3584
    s_mov_b64 exec, -1
    ds_read_b128 v[88:91], v3 offset:4096
    v_exp_f32 v18, v18
    v_exp_f32 v19, v19
    v_exp_f32 v20, v20
    v_mfma_f32_32x32x16_bf16 v[32:47], v[92:95], v[80:83], v[64:79]
    s_setprio 3
    v_exp_f32 v21, v21
    v_exp_f32 v22, v22
    v_exp_f32 v23, v23
    v_exp_f32 v24, v24
    v_pk_mul_f32 v[48:49], v[48:49], v[10:11] op_sel_hi:[1,0]
    v_pk_mul_f32 v[50:51], v[50:51], v[10:11] op_sel_hi:[1,0]
    v_pk_mul_f32 v[52:53], v[52:53], v[10:11] op_sel_hi:[1,0]
    v_pk_mul_f32 v[54:55], v[54:55], v[10:11] op_sel_hi:[1,0]
    v_mul_f32 v56, v10, v56
    s_nop 0
    v_exp_f32 v25, v25
    v_smfmac_f32_32x32x32_bf16 v[48:63], v[96:99], v[16:23], v2
    s_lshl_b32 s51, s3, 12
    s_add_u32 m0, s51, 98304
    s_add_u32 s93, s89, 81920
    buffer_load_dwordx4 v6, s[24:27], s93 offen offset:0 sc1 lds
    v_exp_f32 v26, v26
    v_exp_f32 v27, v27
    v_exp_f32 v28, v28
    v_exp_f32 v29, v29
    v_exp_f32 v30, v30
    v_exp_f32 v31, v31
    v_exp_f32 v32, v32
    v_exp_f32 v33, v33
    v_smfmac_f32_32x32x32_bf16 v[48:63], v[104:107], v[24:31], v2
    s_mov_b64 exec, s[44:45]
    s_waitcnt lgkmcnt(0)
    ds_read_b128 v[96:99], v4 offset:4096
    ds_read_b128 v[104:107], v4 offset:4608
    s_mov_b64 exec, -1
    ds_read_b128 v[92:95], v3 offset:5120
    v_exp_f32 v34, v34
    v_exp_f32 v35, v35
    v_exp_f32 v36, v36
    v_mfma_f32_32x32x16_bf16 v[16:31], v[88:91], v[80:83], v[64:79]
    v_exp_f32 v37, v37
    v_exp_f32 v38, v38
    v_exp_f32 v39, v39
    v_exp_f32 v40, v40
    v_exp_f32 v41, v41
    v_smfmac_f32_32x32x32_bf16 v[48:63], v[100:103], v[32:39], v2
    buffer_load_dwordx4 v6, s[24:27], s93 offen offset:1024 sc1 lds
    v_exp_f32 v42, v42
    v_exp_f32 v43, v43
    v_exp_f32 v44, v44
    v_exp_f32 v45, v45
    v_exp_f32 v46, v46
    v_exp_f32 v47, v47
    v_exp_f32 v16, v16
    v_exp_f32 v17, v17
    v_smfmac_f32_32x32x32_bf16 v[48:63], v[108:111], v[40:47], v2
    s_mov_b64 exec, s[44:45]
    s_waitcnt lgkmcnt(0)
    ds_read_b128 v[100:103], v4 offset:5120
    ds_read_b128 v[108:111], v4 offset:5632
    s_mov_b64 exec, -1
    ds_read_b128 v[88:91], v3 offset:6144
    v_exp_f32 v18, v18
    v_exp_f32 v19, v19
    v_exp_f32 v20, v20
    v_mfma_f32_32x32x16_bf16 v[32:47], v[92:95], v[80:83], v[64:79]
    v_exp_f32 v21, v21
    v_exp_f32 v22, v22
    v_exp_f32 v23, v23
    v_exp_f32 v24, v24
    v_exp_f32 v25, v25
    v_smfmac_f32_32x32x32_bf16 v[48:63], v[96:99], v[16:23], v2
    buffer_load_dwordx4 v6, s[24:27], s93 offen offset:2048 sc1 lds
    v_exp_f32 v26, v26
    v_exp_f32 v27, v27
    v_exp_f32 v28, v28
    v_exp_f32 v29, v29
    v_exp_f32 v30, v30
    v_exp_f32 v31, v31
    v_exp_f32 v32, v32
    v_exp_f32 v33, v33
    v_smfmac_f32_32x32x32_bf16 v[48:63], v[104:107], v[24:31], v2
    s_mov_b64 exec, s[44:45]
    s_waitcnt lgkmcnt(0)
    ds_read_b128 v[96:99], v4 offset:6144
    ds_read_b128 v[104:107], v4 offset:6656
    s_mov_b64 exec, -1
    ds_read_b128 v[92:95], v3 offset:7168
    v_exp_f32 v34, v34
    v_exp_f32 v35, v35
    v_exp_f32 v36, v36
    v_mfma_f32_32x32x16_bf16 v[16:31], v[88:91], v[80:83], v[64:79]
    v_exp_f32 v37, v37
    v_exp_f32 v38, v38
    v_exp_f32 v39, v39
    v_exp_f32 v40, v40
    v_exp_f32 v41, v41
    v_smfmac_f32_32x32x32_bf16 v[48:63], v[100:103], v[32:39], v2
    s_setprio 2
    buffer_load_dwordx4 v6, s[24:27], s93 offen offset:3072 sc1 lds
    v_exp_f32 v42, v42
    v_exp_f32 v43, v43
    v_exp_f32 v44, v44
    v_exp_f32 v45, v45
    v_exp_f32 v46, v46
    v_exp_f32 v47, v47
    v_add_u32 v3, 4294836224, v3
    v_exp_f32 v16, v16
    v_exp_f32 v17, v17
    v_smfmac_f32_32x32x32_bf16 v[48:63], v[108:111], v[40:47], v2
    s_mov_b64 exec, s[44:45]
    s_waitcnt lgkmcnt(0)
    ds_read_b128 v[100:103], v4 offset:7168
    ds_read_b128 v[108:111], v4 offset:7680
    s_mov_b64 exec, -1
    ds_read_b128 v[88:91], v3 offset:0
    v_exp_f32 v18, v18
    v_exp_f32 v19, v19
    v_exp_f32 v20, v20
    v_mfma_f32_32x32x16_bf16 v[32:47], v[92:95], v[80:83], v[64:79]
    v_exp_f32 v21, v21
    v_exp_f32 v22, v22
    v_exp_f32 v23, v23
    v_exp_f32 v24, v24
    v_exp_f32 v25, v25
    v_smfmac_f32_32x32x32_bf16 v[48:63], v[96:99], v[16:23], v2
    v_exp_f32 v26, v26
    v_exp_f32 v27, v27
    v_exp_f32 v28, v28
    v_exp_f32 v29, v29
    v_exp_f32 v30, v30
    v_exp_f32 v31, v31
    v_add_u32 v4, 4294836224, v4
    v_exp_f32 v32, v32
    v_exp_f32 v33, v33
    v_smfmac_f32_32x32x32_bf16 v[48:63], v[104:107], v[24:31], v2
    s_mov_b64 exec, s[44:45]
    s_waitcnt lgkmcnt(0)
    ds_read_b128 v[96:99], v4 offset:0
    ds_read_b128 v[104:107], v4 offset:512
    s_mov_b64 exec, -1
    ds_read_b128 v[92:95], v3 offset:1024
    v_exp_f32 v34, v34
    v_exp_f32 v35, v35
    v_exp_f32 v36, v36
    v_mfma_f32_32x32x16_bf16 v[16:31], v[88:91], v[80:83], v[64:79]
    v_exp_f32 v37, v37
    v_exp_f32 v38, v38
    v_exp_f32 v39, v39
    v_exp_f32 v40, v40
    v_exp_f32 v41, v41
    v_smfmac_f32_32x32x32_bf16 v[48:63], v[100:103], v[32:39], v2
    v_exp_f32 v42, v42
    v_exp_f32 v43, v43
    v_exp_f32 v44, v44
    v_exp_f32 v45, v45
    v_exp_f32 v46, v46
    v_exp_f32 v47, v47
    v_exp_f32 v16, v16
    v_exp_f32 v17, v17
    v_smfmac_f32_32x32x32_bf16 v[48:63], v[108:111], v[40:47], v2
    s_mov_b64 exec, s[44:45]
    s_waitcnt lgkmcnt(0)
    ds_read_b128 v[100:103], v4 offset:1024
    ds_read_b128 v[108:111], v4 offset:1536
    s_mov_b64 exec, -1
    ds_read_b128 v[88:91], v3 offset:2048
    v_exp_f32 v18, v18
    v_exp_f32 v19, v19
    v_exp_f32 v20, v20
    v_mfma_f32_32x32x16_bf16 v[32:47], v[92:95], v[80:83], v[64:79]
    v_exp_f32 v21, v21
    v_exp_f32 v22, v22
    v_exp_f32 v23, v23
    v_exp_f32 v24, v24
    v_exp_f32 v25, v25
    v_smfmac_f32_32x32x32_bf16 v[48:63], v[96:99], v[16:23], v2
    s_setprio 1
    v_exp_f32 v26, v26
    v_exp_f32 v27, v27
    v_exp_f32 v28, v28
    v_exp_f32 v29, v29
    v_exp_f32 v30, v30
    v_exp_f32 v31, v31
    v_exp_f32 v32, v32
    v_exp_f32 v33, v33
    v_smfmac_f32_32x32x32_bf16 v[48:63], v[104:107], v[24:31], v2
    s_mov_b64 exec, s[44:45]
    s_waitcnt lgkmcnt(0)
    ds_read_b128 v[96:99], v4 offset:2048
    ds_read_b128 v[104:107], v4 offset:2560
    s_mov_b64 exec, -1
    ds_read_b128 v[92:95], v3 offset:3072
    v_exp_f32 v34, v34
    v_exp_f32 v35, v35
    v_exp_f32 v36, v36
    v_mfma_f32_32x32x16_bf16 v[16:31], v[88:91], v[80:83], v[64:79]
    s_setprio 0
    v_exp_f32 v37, v37
    v_exp_f32 v38, v38
    v_exp_f32 v39, v39
    v_exp_f32 v40, v40
    v_exp_f32 v41, v41
    v_smfmac_f32_32x32x32_bf16 v[48:63], v[100:103], v[32:39], v2
    s_waitcnt vmcnt(8)
    s_barrier
    v_exp_f32 v42, v42
    v_exp_f32 v43, v43
    v_exp_f32 v44, v44
    v_exp_f32 v45, v45
    v_exp_f32 v46, v46
    v_exp_f32 v47, v47
    v_exp_f32 v16, v16
    v_exp_f32 v17, v17
    v_smfmac_f32_32x32x32_bf16 v[48:63], v[108:111], v[40:47], v2
    s_mov_b64 exec, s[44:45]
    s_waitcnt lgkmcnt(0)
    ds_read_b128 v[100:103], v4 offset:3072
    ds_read_b128 v[108:111], v4 offset:3584
    s_mov_b64 exec, -1
    ds_read_b128 v[88:91], v3 offset:4096
    v_exp_f32 v18, v18
    v_exp_f32 v19, v19
    v_exp_f32 v20, v20
    v_mfma_f32_32x32x16_bf16 v[32:47], v[92:95], v[80:83], v[64:79]
    s_setprio 3
    v_exp_f32 v21, v21
    v_exp_f32 v22, v22
    v_exp_f32 v23, v23
    v_exp_f32 v24, v24
    v_exp_f32 v25, v25
    v_smfmac_f32_32x32x32_bf16 v[48:63], v[96:99], v[16:23], v2
    s_lshl_b32 s51, s3, 12
    s_add_u32 m0, s51, 131072
    s_add_u32 s93, s89, 98304
    buffer_load_dwordx4 v6, s[24:27], s93 offen offset:0 sc1 lds
    v_exp_f32 v26, v26
    v_exp_f32 v27, v27
    v_exp_f32 v28, v28
    v_exp_f32 v29, v29
    v_exp_f32 v30, v30
    v_exp_f32 v31, v31
    v_exp_f32 v32, v32
    v_exp_f32 v33, v33
    v_smfmac_f32_32x32x32_bf16 v[48:63], v[104:107], v[24:31], v2
    s_mov_b64 exec, s[44:45]
    s_waitcnt lgkmcnt(0)
    ds_read_b128 v[96:99], v4 offset:4096
    ds_read_b128 v[104:107], v4 offset:4608
    s_mov_b64 exec, -1
    ds_read_b128 v[92:95], v3 offset:5120
    v_exp_f32 v34, v34
    v_exp_f32 v35, v35
    v_exp_f32 v36, v36
    v_mfma_f32_32x32x16_bf16 v[16:31], v[88:91], v[80:83], v[64:79]
    v_exp_f32 v37, v37
    v_exp_f32 v38, v38
    v_exp_f32 v39, v39
    v_exp_f32 v40, v40
    v_exp_f32 v41, v41
    v_smfmac_f32_32x32x32_bf16 v[48:63], v[100:103], v[32:39], v2
    buffer_load_dwordx4 v6, s[24:27], s93 offen offset:1024 sc1 lds
    v_exp_f32 v42, v42
    v_exp_f32 v43, v43
    v_exp_f32 v44, v44
    v_exp_f32 v45, v45
    v_exp_f32 v46, v46
    v_exp_f32 v47, v47
    v_exp_f32 v16, v16
    v_exp_f32 v17, v17
    v_smfmac_f32_32x32x32_bf16 v[48:63], v[108:111], v[40:47], v2
    s_mov_b64 exec, s[44:45]
    s_waitcnt lgkmcnt(0)
    ds_read_b128 v[100:103], v4 offset:5120
    ds_read_b128 v[108:111], v4 offset:5632
    s_mov_b64 exec, -1
    ds_read_b128 v[88:91], v3 offset:6144
    v_exp_f32 v18, v18
    v_exp_f32 v19, v19
    v_exp_f32 v20, v20
    v_mfma_f32_32x32x16_bf16 v[32:47], v[92:95], v[80:83], v[64:79]
    v_exp_f32 v21, v21
    s_cmp_eq_u32 s3, 0
    s_cbranch_scc1 L_rare_57
L_back_58:
    v_exp_f32 v22, v22
    v_exp_f32 v23, v23
    v_exp_f32 v24, v24
    v_exp_f32 v25, v25
    v_smfmac_f32_32x32x32_bf16 v[48:63], v[96:99], v[16:23], v2
    buffer_load_dwordx4 v6, s[24:27], s93 offen offset:2048 sc1 lds
    v_exp_f32 v26, v26
    v_exp_f32 v27, v27
    v_exp_f32 v28, v28
    v_exp_f32 v29, v29
    v_exp_f32 v30, v30
    v_exp_f32 v31, v31
    v_exp_f32 v32, v32
    v_exp_f32 v33, v33
    v_smfmac_f32_32x32x32_bf16 v[48:63], v[104:107], v[24:31], v2
    s_mov_b64 exec, s[44:45]
    s_waitcnt lgkmcnt(0)
    ds_read_b128 v[96:99], v4 offset:6144
    ds_read_b128 v[104:107], v4 offset:6656
    s_mov_b64 exec, -1
    ds_read_b128 v[92:95], v3 offset:7168
    v_exp_f32 v34, v34
    v_exp_f32 v35, v35
    v_exp_f32 v36, v36
    v_mfma_f32_32x32x16_bf16 v[16:31], v[88:91], v[80:83], v[64:79]
    v_exp_f32 v37, v37
    v_exp_f32 v38, v38
    v_exp_f32 v39, v39
    v_exp_f32 v40, v40
    v_exp_f32 v41, v41
    v_smfmac_f32_32x32x32_bf16 v[48:63], v[100:103], v[32:39], v2
    s_setprio 2
    buffer_load_dwordx4 v6, s[24:27], s93 offen offset:3072 sc1 lds
    v_exp_f32 v42, v42
    v_exp_f32 v43, v43
    v_exp_f32 v44, v44
    v_exp_f32 v45, v45
    v_exp_f32 v46, v46
    v_exp_f32 v47, v47
    v_add_u32 v3, 32768, v3
    v_exp_f32 v16, v16
    v_exp_f32 v17, v17
    v_smfmac_f32_32x32x32_bf16 v[48:63], v[108:111], v[40:47], v2
    s_mov_b64 exec, s[44:45]
    s_waitcnt lgkmcnt(0)
    ds_read_b128 v[100:103], v4 offset:7168
    ds_read_b128 v[108:111], v4 offset:7680
    s_mov_b64 exec, -1
    ds_read_b128 v[88:91], v3 offset:0
    v_exp_f32 v18, v18
    v_exp_f32 v19, v19
    v_exp_f32 v20, v20
    v_mfma_f32_32x32x16_bf16 v[32:47], v[92:95], v[80:83], v[64:79]
    v_exp_f32 v21, v21
    v_exp_f32 v22, v22
    v_exp_f32 v23, v23
    v_exp_f32 v24, v24
    v_exp_f32 v25, v25
    v_smfmac_f32_32x32x32_bf16 v[48:63], v[96:99], v[16:23], v2
    v_exp_f32 v26, v26
    v_exp_f32 v27, v27
    v_exp_f32 v28, v28
    v_exp_f32 v29, v29
    v_exp_f32 v30, v30
    v_exp_f32 v31, v31
    v_add_u32 v4, 32768, v4
    v_exp_f32 v32, v32
    v_exp_f32 v33, v33
    v_smfmac_f32_32x32x32_bf16 v[48:63], v[104:107], v[24:31], v2
    s_mov_b64 exec, s[44:45]
    s_waitcnt lgkmcnt(0)
    ds_read_b128 v[96:99], v4 offset:0
    ds_read_b128 v[104:107], v4 offset:512
    s_mov_b64 exec, -1
    ds_read_b128 v[92:95], v3 offset:1024
    v_exp_f32 v34, v34
    v_exp_f32 v35, v35
    v_exp_f32 v36, v36
    v_mfma_f32_32x32x16_bf16 v[16:31], v[88:91], v[80:83], v[64:79]
    v_exp_f32 v37, v37
    v_exp_f32 v38, v38
    v_exp_f32 v39, v39
    v_exp_f32 v40, v40
    v_exp_f32 v41, v41
    v_smfmac_f32_32x32x32_bf16 v[48:63], v[100:103], v[32:39], v2
    v_exp_f32 v42, v42
    v_exp_f32 v43, v43
    v_exp_f32 v44, v44
    v_exp_f32 v45, v45
    v_exp_f32 v46, v46
    v_exp_f32 v47, v47
    v_exp_f32 v16, v16
    v_exp_f32 v17, v17
    v_smfmac_f32_32x32x32_bf16 v[48:63], v[108:111], v[40:47], v2
    s_mov_b64 exec, s[44:45]
    s_waitcnt lgkmcnt(0)
    ds_read_b128 v[100:103], v4 offset:1024
    ds_read_b128 v[108:111], v4 offset:1536
    s_mov_b64 exec, -1
    ds_read_b128 v[88:91], v3 offset:2048
    v_exp_f32 v18, v18
    v_exp_f32 v19, v19
    v_exp_f32 v20, v20
    v_mfma_f32_32x32x16_bf16 v[32:47], v[92:95], v[80:83], v[64:79]
    v_exp_f32 v21, v21
    v_exp_f32 v22, v22
    v_exp_f32 v23, v23
    v_exp_f32 v24, v24
    v_exp_f32 v25, v25
    v_smfmac_f32_32x32x32_bf16 v[48:63], v[96:99], v[16:23], v2
    s_setprio 1
    v_exp_f32 v26, v26
    v_exp_f32 v27, v27
    v_exp_f32 v28, v28
    v_exp_f32 v29, v29
    v_exp_f32 v30, v30
    v_exp_f32 v31, v31
    v_exp_f32 v32, v32
    v_exp_f32 v33, v33
    v_smfmac_f32_32x32x32_bf16 v[48:63], v[104:107], v[24:31], v2
    s_mov_b64 exec, s[44:45]
    s_waitcnt lgkmcnt(0)
    ds_read_b128 v[96:99], v4 offset:2048
    ds_read_b128 v[104:107], v4 offset:2560
    s_mov_b64 exec, -1
    ds_read_b128 v[92:95], v3 offset:3072
    v_exp_f32 v34, v34
    v_exp_f32 v35, v35
    v_exp_f32 v36, v36
    v_mfma_f32_32x32x16_bf16 v[16:31], v[88:91], v[80:83], v[64:79]
    s_setprio 0
    v_exp_f32 v37, v37
    v_exp_f32 v38, v38
    v_exp_f32 v39, v39
    v_exp_f32 v40, v40
    v_exp_f32 v41, v41
    v_smfmac_f32_32x32x32_bf16 v[48:63], v[100:103], v[32:39], v2
    s_waitcnt vmcnt(8)
    s_barrier
    v_exp_f32 v42, v42
    v_exp_f32 v43, v43
    v_exp_f32 v44, v44
    v_exp_f32 v45, v45
    v_exp_f32 v46, v46
    v_exp_f32 v47, v47
    v_exp_f32 v16, v16
    v_exp_f32 v17, v17
    v_smfmac_f32_32x32x32_bf16 v[48:63], v[108:111], v[40:47], v2
    s_mov_b64 exec, s[44:45]
    s_waitcnt lgkmcnt(0)
    ds_read_b128 v[100:103], v4 offset:3072
    ds_read_b128 v[108:111], v4 offset:3584
    s_mov_b64 exec, -1
    ds_read_b128 v[88:91], v3 offset:4096
    v_exp_f32 v18, v18
    v_exp_f32 v19, v19
    v_exp_f32 v20, v20
    v_mfma_f32_32x32x16_bf16 v[32:47], v[92:95], v[80:83], v[64:79]
    s_setprio 3
    v_exp_f32 v21, v21
    v_exp_f32 v22, v22
    v_exp_f32 v23, v23
    v_exp_f32 v24, v24
    v_exp_f32 v25, v25
    v_smfmac_f32_32x32x32_bf16 v[48:63], v[96:99], v[16:23], v2
    s_lshl_b32 s51, s3, 12
    s_add_u32 m0, s51, 0
    s_add_u32 s93, s89, 114688
    buffer_load_dwordx4 v6, s[24:27], s93 offen offset:0 sc1 lds
    v_exp_f32 v26, v26
    v_exp_f32 v27, v27
    v_exp_f32 v28, v28
    v_exp_f32 v29, v29
    v_exp_f32 v30, v30
    v_exp_f32 v31, v31
    v_exp_f32 v32, v32
    v_exp_f32 v33, v33
    v_smfmac_f32_32x32x32_bf16 v[48:63], v[104:107], v[24:31], v2
    s_mov_b64 exec, s[44:45]
    s_waitcnt lgkmcnt(0)
    ds_read_b128 v[96:99], v4 offset:4096
    ds_read_b128 v[104:107], v4 offset:4608
    s_mov_b64 exec, -1
    ds_read_b128 v[92:95], v3 offset:5120
    v_exp_f32 v34, v34
    v_exp_f32 v35, v35
    v_exp_f32 v36, v36
    v_mfma_f32_32x32x16_bf16 v[16:31], v[88:91], v[80:83], v[64:79]
    v_exp_f32 v37, v37
    v_exp_f32 v38, v38
    v_exp_f32 v39, v39
    v_exp_f32 v40, v40
    v_exp_f32 v41, v41
    v_smfmac_f32_32x32x32_bf16 v[48:63], v[100:103], v[32:39], v2
    buffer_load_dwordx4 v6, s[24:27], s93 offen offset:1024 sc1 lds
    v_exp_f32 v42, v42
    v_exp_f32 v43, v43
    v_exp_f32 v44, v44
    v_exp_f32 v45, v45
    v_exp_f32 v46, v46
    v_exp_f32 v47, v47
    v_exp_f32 v16, v16
    v_exp_f32 v17, v17
    v_smfmac_f32_32x32x32_bf16 v[48:63], v[108:111], v[40:47], v2
    s_mov_b64 exec, s[44:45]
    s_waitcnt lgkmcnt(0)
    ds_read_b128 v[100:103], v4 offset:5120
    ds_read_b128 v[108:111], v4 offset:5632
    s_mov_b64 exec, -1
    ds_read_b128 v[88:91], v3 offset:6144
    v_exp_f32 v18, v18
    v_exp_f32 v19, v19
    v_exp_f32 v20, v20
    v_mfma_f32_32x32x16_bf16 v[32:47], v[92:95], v[80:83], v[64:79]
    v_exp_f32 v21, v21
    v_exp_f32 v22, v22
    v_exp_f32 v23, v23
    v_exp_f32 v24, v24
    v_exp_f32 v25, v25
    v_smfmac_f32_32x32x32_bf16 v[48:63], v[96:99], v[16:23], v2
    buffer_load_dwordx4 v6, s[24:27], s93 offen offset:2048 sc1 lds
    v_exp_f32 v26, v26
    v_exp_f32 v27, v27
    v_exp_f32 v28, v28
    v_exp_f32 v29, v29
    v_exp_f32 v30, v30
    v_exp_f32 v31, v31
    v_exp_f32 v32, v32
    v_exp_f32 v33, v33
    v_smfmac_f32_32x32x32_bf16 v[48:63], v[104:107], v[24:31], v2
    s_mov_b64 exec, s[44:45]
    s_waitcnt lgkmcnt(0)
    ds_read_b128 v[96:99], v4 offset:6144
    ds_read_b128 v[104:107], v4 offset:6656
    s_mov_b64 exec, -1
    ds_read_b128 v[92:95], v3 offset:7168
    v_exp_f32 v34, v34
    v_exp_f32 v35, v35
    v_exp_f32 v36, v36
    v_mfma_f32_32x32x16_bf16 v[16:31], v[88:91], v[80:83], v[64:79]
    v_exp_f32 v37, v37
    v_exp_f32 v38, v38
    v_exp_f32 v39, v39
    v_exp_f32 v40, v40
    v_exp_f32 v41, v41
    v_smfmac_f32_32x32x32_bf16 v[48:63], v[100:103], v[32:39], v2
    s_setprio 2
    buffer_load_dwordx4 v6, s[24:27], s93 offen offset:3072 sc1 lds
    v_exp_f32 v42, v42
    v_exp_f32 v43, v43
    v_exp_f32 v44, v44
    v_exp_f32 v45, v45
    v_exp_f32 v46, v46
    v_exp_f32 v47, v47
    v_add_u32 v3, 32768, v3
    v_exp_f32 v16, v16
    v_exp_f32 v17, v17
    v_smfmac_f32_32x32x32_bf16 v[48:63], v[108:111], v[40:47], v2
    s_mov_b64 exec, s[44:45]
    s_waitcnt lgkmcnt(0)
    ds_read_b128 v[100:103], v4 offset:7168
    ds_read_b128 v[108:111], v4 offset:7680
    s_mov_b64 exec, -1
    ds_read_b128 v[88:91], v3 offset:0
    v_exp_f32 v18, v18
    v_exp_f32 v19, v19
    v_exp_f32 v20, v20
    v_mfma_f32_32x32x16_bf16 v[32:47], v[92:95], v[80:83], v[64:79]
    v_exp_f32 v21, v21
    v_exp_f32 v22, v22
    v_exp_f32 v23, v23
    v_exp_f32 v24, v24
    v_exp_f32 v25, v25
    v_smfmac_f32_32x32x32_bf16 v[48:63], v[96:99], v[16:23], v2
    v_exp_f32 v26, v26
    v_exp_f32 v27, v27
    v_exp_f32 v28, v28
    v_exp_f32 v29, v29
    v_exp_f32 v30, v30
    v_exp_f32 v31, v31
    v_add_u32 v4, 32768, v4
    v_exp_f32 v32, v32
    v_exp_f32 v33, v33
    v_smfmac_f32_32x32x32_bf16 v[48:63], v[104:107], v[24:31], v2
    s_mov_b64 exec, s[44:45]
    s_waitcnt lgkmcnt(0)
    ds_read_b128 v[96:99], v4 offset:0
    ds_read_b128 v[104:107], v4 offset:512
    s_mov_b64 exec, -1
    ds_read_b128 v[92:95], v3 offset:1024
    v_exp_f32 v34, v34
    v_exp_f32 v35, v35
    v_exp_f32 v36, v36
    v_mfma_f32_32x32x16_bf16 v[16:31], v[88:91], v[80:83], v[64:79]
    v_exp_f32 v37, v37
    v_exp_f32 v38, v38
    v_exp_f32 v39, v39
    v_exp_f32 v40, v40
    v_exp_f32 v41, v41
    v_smfmac_f32_32x32x32_bf16 v[48:63], v[100:103], v[32:39], v2
    v_exp_f32 v42, v42
    v_exp_f32 v43, v43
    v_exp_f32 v44, v44
    v_exp_f32 v45, v45
    v_exp_f32 v46, v46
    v_exp_f32 v47, v47
    v_exp_f32 v16, v16
    v_exp_f32 v17, v17
    v_smfmac_f32_32x32x32_bf16 v[48:63], v[108:111], v[40:47], v2
    s_mov_b64 exec, s[44:45]
    s_waitcnt lgkmcnt(0)
    ds_read_b128 v[100:103], v4 offset:1024
    ds_read_b128 v[108:111], v4 offset:1536
    s_mov_b64 exec, -1
    ds_read_b128 v[88:91], v3 offset:2048
    v_exp_f32 v18, v18
    v_exp_f32 v19, v19
    v_exp_f32 v20, v20
    v_mfma_f32_32x32x16_bf16 v[32:47], v[92:95], v[80:83], v[64:79]
    v_exp_f32 v21, v21
    v_exp_f32 v22, v22
    v_exp_f32 v23, v23
    v_exp_f32 v24, v24
    v_exp_f32 v25, v25
    v_smfmac_f32_32x32x32_bf16 v[48:63], v[96:99], v[16:23], v2
    s_setprio 1
    v_exp_f32 v26, v26
    v_exp_f32 v27, v27
    v_exp_f32 v28, v28
    v_exp_f32 v29, v29
    v_exp_f32 v30, v30
    v_exp_f32 v31, v31
    v_exp_f32 v32, v32
    v_exp_f32 v33, v33
    v_smfmac_f32_32x32x32_bf16 v[48:63], v[104:107], v[24:31], v2
    s_mov_b64 exec, s[44:45]
    s_waitcnt lgkmcnt(0)
    ds_read_b128 v[96:99], v4 offset:2048
    ds_read_b128 v[104:107], v4 offset:2560
    s_mov_b64 exec, -1
    ds_read_b128 v[92:95], v3 offset:3072
    v_exp_f32 v34, v34
    v_exp_f32 v35, v35
    v_exp_f32 v36, v36
    v_mfma_f32_32x32x16_bf16 v[16:31], v[88:91], v[80:83], v[64:79]
    s_setprio 0
    v_exp_f32 v37, v37
    v_exp_f32 v38, v38
    v_exp_f32 v39, v39
    v_exp_f32 v40, v40
    v_exp_f32 v41, v41
    v_smfmac_f32_32x32x32_bf16 v[48:63], v[100:103], v[32:39], v2
    s_waitcnt vmcnt(8)
    s_barrier
    v_exp_f32 v42, v42
    v_exp_f32 v43, v43
    v_exp_f32 v44, v44
    v_exp_f32 v45, v45
    v_exp_f32 v46, v46
    v_exp_f32 v47, v47
    v_exp_f32 v16, v16
    v_exp_f32 v17, v17
    v_smfmac_f32_32x32x32_bf16 v[48:63], v[108:111], v[40:47], v2
    s_mov_b64 exec, s[44:45]
    s_waitcnt lgkmcnt(0)
    ds_read_b128 v[100:103], v4 offset:3072
    ds_read_b128 v[108:111], v4 offset:3584
    s_mov_b64 exec, -1
    ds_read_b128 v[88:91], v3 offset:4096
    v_exp_f32 v18, v18
    v_exp_f32 v19, v19
    v_exp_f32 v20, v20
    v_mfma_f32_32x32x16_bf16 v[32:47], v[92:95], v[80:83], v[64:79]
    s_setprio 3
    v_exp_f32 v21, v21
    v_exp_f32 v22, v22
    v_exp_f32 v23, v23
    v_exp_f32 v24, v24
    v_exp_f32 v25, v25
    v_smfmac_f32_32x32x32_bf16 v[48:63], v[96:99], v[16:23], v2
    s_lshl_b32 s93, s3, 15
    s_and_b32 s50, s4, 7
    s_lshl_b32 s50, s50, 7
    s_add_u32 s93, s93, s50
    s_lshl_b32 s51, s3, 12
    s_add_u32 m0, s51, 32768
    s_add_u32 s50, s93, 0
    buffer_load_dwordx4 v224, s[40:43], s50 offen lds
    v_exp_f32 v26, v26
    v_exp_f32 v27, v27
    v_exp_f32 v28, v28
    v_exp_f32 v29, v29
    v_exp_f32 v30, v30
    v_exp_f32 v31, v31
    v_exp_f32 v32, v32
    v_exp_f32 v33, v33
    v_smfmac_f32_32x32x32_bf16 v[48:63], v[104:107], v[24:31], v2
    s_mov_b64 exec, s[44:45]
    s_waitcnt lgkmcnt(0)
    ds_read_b128 v[96:99], v4 offset:4096
    ds_read_b128 v[104:107], v4 offset:4608
    s_mov_b64 exec, -1
    ds_read_b128 v[92:95], v3 offset:5120
    v_exp_f32 v34, v34
    v_exp_f32 v35, v35
    v_exp_f32 v36, v36
    v_mfma_f32_32x32x16_bf16 v[16:31], v[88:91], v[80:83], v[64:79]
    v_exp_f32 v37, v37
    v_exp_f32 v38, v38
    v_exp_f32 v39, v39
    v_exp_f32 v40, v40
    v_exp_f32 v41, v41
    v_smfmac_f32_32x32x32_bf16 v[48:63], v[100:103], v[32:39], v2
    s_lshl_b32 s51, s3, 12
    s_add_u32 m0, s51, 33792
    s_add_u32 s50, s93, 8192
    buffer_load_dwordx4 v224, s[40:43], s50 offen lds
    v_exp_f32 v42, v42
    v_exp_f32 v43, v43
    v_exp_f32 v44, v44
    v_exp_f32 v45, v45
    v_exp_f32 v46, v46
    v_exp_f32 v47, v47
    v_exp_f32 v16, v16
    v_exp_f32 v17, v17
    v_smfmac_f32_32x32x32_bf16 v[48:63], v[108:111], v[40:47], v2
    s_mov_b64 exec, s[44:45]
    s_waitcnt lgkmcnt(0)
    ds_read_b128 v[100:103], v4 offset:5120
    ds_read_b128 v[108:111], v4 offset:5632
    s_mov_b64 exec, -1
    ds_read_b128 v[88:91], v3 offset:6144
    v_exp_f32 v18, v18
    v_exp_f32 v19, v19
    v_exp_f32 v20, v20
    v_mfma_f32_32x32x16_bf16 v[32:47], v[92:95], v[80:83], v[64:79]
    v_exp_f32 v21, v21
    v_exp_f32 v22, v22
    v_exp_f32 v23, v23
    v_exp_f32 v24, v24
    v_exp_f32 v25, v25
    v_smfmac_f32_32x32x32_bf16 v[48:63], v[96:99], v[16:23], v2
    s_lshl_b32 s51, s3, 12
    s_add_u32 m0, s51, 34816
    s_add_u32 s50, s93, 16384
    buffer_load_dwordx4 v224, s[40:43], s50 offen lds
    v_exp_f32 v26, v26
    v_exp_f32 v27, v27
    v_exp_f32 v28, v28
    v_exp_f32 v29, v29
    v_exp_f32 v30, v30
    v_exp_f32 v31, v31
    v_exp_f32 v32, v32
    v_exp_f32 v33, v33
    v_smfmac_f32_32x32x32_bf16 v[48:63], v[104:107], v[24:31], v2
    s_mov_b64 exec, s[44:45]
    s_waitcnt lgkmcnt(0)
    ds_read_b128 v[96:99], v4 offset:6144
    ds_read_b128 v[104:107], v4 offset:6656
    s_mov_b64 exec, -1
    ds_read_b128 v[92:95], v3 offset:7168
    v_exp_f32 v34, v34
    v_exp_f32 v35, v35
    v_exp_f32 v36, v36
    v_mfma_f32_32x32x16_bf16 v[16:31], v[88:91], v[80:83], v[64:79]
    v_exp_f32 v37, v37
    v_exp_f32 v38, v38
    v_exp_f32 v39, v39
    v_exp_f32 v40, v40
    v_exp_f32 v41, v41
    v_smfmac_f32_32x32x32_bf16 v[48:63], v[100:103], v[32:39], v2
    s_setprio 2
    s_lshl_b32 s51, s3, 12
    s_add_u32 m0, s51, 35840
    s_add_u32 s50, s93, 24576
    buffer_load_dwordx4 v224, s[40:43], s50 offen lds
    v_exp_f32 v42, v42
    v_exp_f32 v43, v43
    v_exp_f32 v44, v44
    v_exp_f32 v45, v45
    v_exp_f32 v46, v46
    v_exp_f32 v47, v47
    v_add_u32 v3, 32768, v3
    v_exp_f32 v16, v16
    v_exp_f32 v17, v17
    v_smfmac_f32_32x32x32_bf16 v[48:63], v[108:111], v[40:47], v2
    s_mov_b64 exec, s[44:45]
    s_waitcnt lgkmcnt(0)
    ds_read_b128 v[100:103], v4 offset:7168
    ds_read_b128 v[108:111], v4 offset:7680
    s_mov_b64 exec, -1
    ds_read_b128 v[88:91], v3 offset:0
    v_exp_f32 v18, v18
    v_exp_f32 v19, v19
    v_exp_f32 v20, v20
    v_mfma_f32_32x32x16_bf16 v[32:47], v[92:95], v[80:83], v[64:79]
    v_exp_f32 v21, v21
    v_exp_f32 v22, v22
    v_exp_f32 v23, v23
    v_exp_f32 v24, v24
    v_exp_f32 v25, v25
    v_smfmac_f32_32x32x32_bf16 v[48:63], v[96:99], v[16:23], v2
    v_exp_f32 v26, v26
    v_exp_f32 v27, v27
    v_exp_f32 v28, v28
    v_exp_f32 v29, v29
    v_exp_f32 v30, v30
    v_exp_f32 v31, v31
    v_add_u32 v4, 32768, v4
    v_exp_f32 v32, v32
    v_exp_f32 v33, v33
    v_smfmac_f32_32x32x32_bf16 v[48:63], v[104:107], v[24:31], v2
    s_mov_b64 exec, s[44:45]
    s_waitcnt lgkmcnt(0)
    ds_read_b128 v[96:99], v4 offset:0
    ds_read_b128 v[104:107], v4 offset:512
    s_mov_b64 exec, -1
    ds_read_b128 v[92:95], v3 offset:1024
    v_exp_f32 v34, v34
    v_exp_f32 v35, v35
    v_exp_f32 v36, v36
    v_mfma_f32_32x32x16_bf16 v[16:31], v[88:91], v[80:83], v[64:79]
    v_exp_f32 v37, v37
    v_exp_f32 v38, v38
    v_exp_f32 v39, v39
    v_exp_f32 v40, v40
    v_exp_f32 v41, v41
    v_smfmac_f32_32x32x32_bf16 v[48:63], v[100:103], v[32:39], v2
    v_exp_f32 v42, v42
    v_exp_f32 v43, v43
    v_exp_f32 v44, v44
    v_exp_f32 v45, v45
    v_exp_f32 v46, v46
    v_exp_f32 v47, v47
    v_exp_f32 v16, v16
    v_exp_f32 v17, v17
    v_smfmac_f32_32x32x32_bf16 v[48:63], v[108:111], v[40:47], v2
    s_mov_b64 exec, s[44:45]
    s_waitcnt lgkmcnt(0)
    ds_read_b128 v[100:103], v4 offset:1024
    ds_read_b128 v[108:111], v4 offset:1536
    s_mov_b64 exec, -1
    ds_read_b128 v[88:91], v3 offset:2048
    v_exp_f32 v18, v18
    v_exp_f32 v19, v19
    v_exp_f32 v20, v20
    v_mfma_f32_32x32x16_bf16 v[32:47], v[92:95], v[80:83], v[64:79]
    v_exp_f32 v21, v21
    v_exp_f32 v22, v22
    v_exp_f32 v23, v23
    v_exp_f32 v24, v24
    v_exp_f32 v25, v25
    v_smfmac_f32_32x32x32_bf16 v[48:63], v[96:99], v[16:23], v2
    s_setprio 1
    v_exp_f32 v26, v26
    v_exp_f32 v27, v27
    v_exp_f32 v28, v28
    v_exp_f32 v29, v29
    v_exp_f32 v30, v30
    v_exp_f32 v31, v31
    v_exp_f32 v32, v32
    v_exp_f32 v33, v33
    v_smfmac_f32_32x32x32_bf16 v[48:63], v[104:107], v[24:31], v2
    s_mov_b64 exec, s[44:45]
    s_waitcnt lgkmcnt(0)
    ds_read_b128 v[96:99], v4 offset:2048
    ds_read_b128 v[104:107], v4 offset:2560
    s_mov_b64 exec, -1
    ds_read_b128 v[92:95], v3 offset:3072
    v_exp_f32 v34, v34
    v_exp_f32 v35, v35
    v_exp_f32 v36, v36
    v_mfma_f32_32x32x16_bf16 v[16:31], v[88:91], v[80:83], v[64:79]
    s_setprio 0
    v_exp_f32 v37, v37
    v_exp_f32 v38, v38
    v_exp_f32 v39, v39
    v_exp_f32 v40, v40
    v_exp_f32 v41, v41
    v_smfmac_f32_32x32x32_bf16 v[48:63], v[100:103], v[32:39], v2
    s_waitcnt vmcnt(8)
    s_barrier
    v_exp_f32 v42, v42
    v_exp_f32 v43, v43
    v_exp_f32 v44, v44
    v_exp_f32 v45, v45
    v_exp_f32 v46, v46
    v_exp_f32 v47, v47
    s_cmp_eq_u32 s3, 0
    s_cbranch_scc1 L_rare_59
L_back_60:
    v_exp_f32 v16, v16
    v_exp_f32 v17, v17
    v_smfmac_f32_32x32x32_bf16 v[48:63], v[108:111], v[40:47], v2
    s_mov_b64 exec, s[44:45]
    s_waitcnt lgkmcnt(0)
    ds_read_b128 v[100:103], v4 offset:3072
    ds_read_b128 v[108:111], v4 offset:3584
    s_mov_b64 exec, -1
    ds_read_b128 v[88:91], v3 offset:4096
    v_exp_f32 v18, v18
    v_exp_f32 v19, v19
    v_exp_f32 v20, v20
    v_mfma_f32_32x32x16_bf16 v[32:47], v[92:95], v[80:83], v[64:79]
    s_setprio 3
    v_exp_f32 v21, v21
    v_exp_f32 v22, v22
    v_exp_f32 v23, v23
    v_exp_f32 v24, v24
    v_exp_f32 v25, v25
    v_smfmac_f32_32x32x32_bf16 v[48:63], v[96:99], v[16:23], v2
    s_lshl_b32 s93, s3, 15
    s_and_b32 s50, s4, 7
    s_lshl_b32 s50, s50, 7
    s_add_u32 s93, s93, s50
    s_lshl_b32 s51, s3, 12
    s_add_u32 m0, s51, 65536
    s_add_u32 s50, s93, 262144
    buffer_load_dwordx4 v224, s[40:43], s50 offen lds
    v_exp_f32 v26, v26
    v_exp_f32 v27, v27
    v_exp_f32 v28, v28
    v_exp_f32 v29, v29
    v_exp_f32 v30, v30
    v_exp_f32 v31, v31
    v_exp_f32 v32, v32
    v_exp_f32 v33, v33
    v_smfmac_f32_32x32x32_bf16 v[48:63], v[104:107], v[24:31], v2
    s_mov_b64 exec, s[44:45]
    s_waitcnt lgkmcnt(0)
    ds_read_b128 v[96:99], v4 offset:4096
    ds_read_b128 v[104:107], v4 offset:4608
    s_mov_b64 exec, -1
    ds_read_b128 v[92:95], v3 offset:5120
    v_exp_f32 v34, v34
    v_exp_f32 v35, v35
    v_exp_f32 v36, v36
    v_mfma_f32_32x32x16_bf16 v[16:31], v[88:91], v[80:83], v[64:79]
    v_exp_f32 v37, v37
    v_exp_f32 v38, v38
    v_exp_f32 v39, v39
    v_exp_f32 v40, v40
    v_exp_f32 v41, v41
    v_smfmac_f32_32x32x32_bf16 v[48:63], v[100:103], v[32:39], v2
    s_lshl_b32 s51, s3, 12
    s_add_u32 m0, s51, 66560
    s_add_u32 s50, s93, 270336
    buffer_load_dwordx4 v224, s[40:43], s50 offen lds
    v_exp_f32 v42, v42
    v_exp_f32 v43, v43
    v_exp_f32 v44, v44
    v_exp_f32 v45, v45
    v_exp_f32 v46, v46
    v_exp_f32 v47, v47
    v_exp_f32 v16, v16
    v_exp_f32 v17, v17
    v_smfmac_f32_32x32x32_bf16 v[48:63], v[108:111], v[40:47], v2
    s_mov_b64 exec, s[44:45]
    s_waitcnt lgkmcnt(0)
    ds_read_b128 v[100:103], v4 offset:5120
    ds_read_b128 v[108:111], v4 offset:5632
    s_mov_b64 exec, -1
    ds_read_b128 v[88:91], v3 offset:6144
    v_exp_f32 v18, v18
    v_exp_f32 v19, v19
    v_exp_f32 v20, v20
    v_mfma_f32_32x32x16_bf16 v[32:47], v[92:95], v[80:83], v[64:79]
    v_exp_f32 v21, v21
    v_exp_f32 v22, v22
    v_exp_f32 v23, v23
    v_exp_f32 v24, v24
    v_exp_f32 v25, v25
    v_smfmac_f32_32x32x32_bf16 v[48:63], v[96:99], v[16:23], v2
    s_lshl_b32 s51, s3, 12
    s_add_u32 m0, s51, 67584
    s_add_u32 s50, s93, 278528
    buffer_load_dwordx4 v224, s[40:43], s50 offen lds
    v_exp_f32 v26, v26
    v_exp_f32 v27, v27
    v_exp_f32 v28, v28
    v_exp_f32 v29, v29
    v_exp_f32 v30, v30
    v_exp_f32 v31, v31
    v_exp_f32 v32, v32
    v_exp_f32 v33, v33
    v_smfmac_f32_32x32x32_bf16 v[48:63], v[104:107], v[24:31], v2
    s_mov_b64 exec, s[44:45]
    s_waitcnt lgkmcnt(0)
    ds_read_b128 v[96:99], v4 offset:6144
    ds_read_b128 v[104:107], v4 offset:6656
    s_mov_b64 exec, -1
    ds_read_b128 v[92:95], v3 offset:7168
    v_exp_f32 v34, v34
    v_exp_f32 v35, v35
    v_exp_f32 v36, v36
    v_mfma_f32_32x32x16_bf16 v[16:31], v[88:91], v[80:83], v[64:79]
    v_exp_f32 v37, v37
    s_and_b32 s50, s5, 3
    s_lshl_b32 s50, s50, 13
    s_add_u32 s50, s50, s93
    s_add_u32 s50, s50, 262144
    buffer_load_dwordx4 v[216:219], v224, s[36:39], s50 offen
    v_exp_f32 v38, v38
    v_exp_f32 v39, v39
    v_exp_f32 v40, v40
    v_exp_f32 v41, v41
    v_smfmac_f32_32x32x32_bf16 v[48:63], v[100:103], v[32:39], v2
    s_setprio 2
    s_lshl_b32 s51, s3, 12
    s_add_u32 m0, s51, 68608
    s_add_u32 s50, s93, 286720
    buffer_load_dwordx4 v224, s[40:43], s50 offen lds
    v_exp_f32 v42, v42
    v_exp_f32 v43, v43
    v_exp_f32 v44, v44
    v_exp_f32 v45, v45
    v_exp_f32 v46, v46
    v_exp_f32 v47, v47
    v_add_u32 v3, 32768, v3
    v_exp_f32 v16, v16
    v_exp_f32 v17, v17
    v_smfmac_f32_32x32x32_bf16 v[48:63], v[108:111], v[40:47], v2
    s_mov_b64 exec, s[44:45]
    s_waitcnt lgkmcnt(0)
    ds_read_b128 v[100:103], v4 offset:7168
    ds_read_b128 v[108:111], v4 offset:7680
    s_mov_b64 exec, -1
    ds_read_b128 v[88:91], v3 offset:0
    v_exp_f32 v18, v18
    v_exp_f32 v19, v19
    v_exp_f32 v20, v20
    v_mfma_f32_32x32x16_bf16 v[32:47], v[92:95], v[80:83], v[64:79]
    v_exp_f32 v21, v21
    v_exp_f32 v22, v22
    v_exp_f32 v23, v23
    v_exp_f32 v24, v24
    v_exp_f32 v25, v25
    v_smfmac_f32_32x32x32_bf16 v[48:63], v[96:99], v[16:23], v2
    v_exp_f32 v26, v26
    v_exp_f32 v27, v27
    v_exp_f32 v28, v28
    v_exp_f32 v29, v29
    v_exp_f32 v30, v30
    v_exp_f32 v31, v31
    v_add_u32 v4, 32768, v4
    v_exp_f32 v32, v32
    v_exp_f32 v33, v33
    v_smfmac_f32_32x32x32_bf16 v[48:63], v[104:107], v[24:31], v2
    s_mov_b64 exec, s[44:45]
    s_waitcnt lgkmcnt(0)
    ds_read_b128 v[96:99], v4 offset:0
    ds_read_b128 v[104:107], v4 offset:512
    s_mov_b64 exec, -1
    ds_read_b128 v[92:95], v3 offset:1024
    v_exp_f32 v34, v34
    v_exp_f32 v35, v35
    v_exp_f32 v36, v36
    v_mfma_f32_32x32x16_bf16 v[16:31], v[88:91], v[80:83], v[64:79]
    v_exp_f32 v37, v37
    v_exp_f32 v38, v38
    v_exp_f32 v39, v39
    v_exp_f32 v40, v40
    v_exp_f32 v41, v41
    v_smfmac_f32_32x32x32_bf16 v[48:63], v[100:103], v[32:39], v2
    v_exp_f32 v42, v42
    v_exp_f32 v43, v43
    v_exp_f32 v44, v44
    v_exp_f32 v45, v45
    v_exp_f32 v46, v46
    v_exp_f32 v47, v47
    v_exp_f32 v16, v16
    v_exp_f32 v17, v17
    v_smfmac_f32_32x32x32_bf16 v[48:63], v[108:111], v[40:47], v2
    s_mov_b64 exec, s[44:45]
    s_waitcnt lgkmcnt(0)
    ds_read_b128 v[100:103], v4 offset:1024
    ds_read_b128 v[108:111], v4 offset:1536
    s_mov_b64 exec, -1
    ds_read_b128 v[88:91], v3 offset:2048
    v_exp_f32 v18, v18
    v_exp_f32 v19, v19
    v_exp_f32 v20, v20
    v_mfma_f32_32x32x16_bf16 v[32:47], v[92:95], v[80:83], v[64:79]
    v_exp_f32 v21, v21
    v_exp_f32 v22, v22
    v_exp_f32 v23, v23
    v_exp_f32 v24, v24
    v_exp_f32 v25, v25
    v_smfmac_f32_32x32x32_bf16 v[48:63], v[96:99], v[16:23], v2
    s_setprio 1
    v_exp_f32 v26, v26
    v_exp_f32 v27, v27
    v_exp_f32 v28, v28
    v_exp_f32 v29, v29
    v_exp_f32 v30, v30
    v_exp_f32 v31, v31
    v_exp_f32 v32, v32
    s_waitcnt vmcnt(5)
    s_cmp_eq_u32 s3, 0
    s_cbranch_scc1 L_rare_61
L_back_62:
    v_exp_f32 v33, v33
    v_smfmac_f32_32x32x32_bf16 v[48:63], v[104:107], v[24:31], v2
    s_mov_b64 exec, s[44:45]
    s_waitcnt lgkmcnt(0)
    ds_read_b128 v[96:99], v4 offset:2048
    ds_read_b128 v[104:107], v4 offset:2560
    s_mov_b64 exec, -1
    ds_read_b128 v[92:95], v3 offset:3072
    v_exp_f32 v34, v34
    v_exp_f32 v35, v35
    v_exp_f32 v36, v36
    v_mfma_f32_32x32x16_bf16 v[16:31], v[88:91], v[80:83], v[64:79]
    s_setprio 0
    v_exp_f32 v37, v37
    v_exp_f32 v38, v38
    v_exp_f32 v39, v39
    v_exp_f32 v40, v40
    v_exp_f32 v41, v41
    v_smfmac_f32_32x32x32_bf16 v[48:63], v[100:103], v[32:39], v2
    s_barrier
    v_exp_f32 v42, v42
    v_exp_f32 v43, v43
    v_exp_f32 v44, v44
    v_exp_f32 v45, v45
    v_exp_f32 v46, v46
    v_exp_f32 v47, v47
    v_exp_f32 v16, v16
    v_exp_f32 v17, v17
    v_smfmac_f32_32x32x32_bf16 v[48:63], v[108:111], v[40:47], v2
    s_mov_b64 exec, s[44:45]
    s_waitcnt lgkmcnt(0)
    ds_read_b128 v[100:103], v4 offset:3072
    ds_read_b128 v[108:111], v4 offset:3584
    s_mov_b64 exec, -1
    ds_read_b128 v[88:91], v3 offset:4096
    v_exp_f32 v18, v18
    v_exp_f32 v19, v19
    v_exp_f32 v20, v20
    v_mfma_f32_32x32x16_bf16 v[32:47], v[92:95], v[80:83], v[64:79]
    s_setprio 3
    v_exp_f32 v21, v21
    v_exp_f32 v22, v22
    v_exp_f32 v23, v23
    v_exp_f32 v24, v24
    v_exp_f32 v25, v25
    v_smfmac_f32_32x32x32_bf16 v[48:63], v[96:99], v[16:23], v2
    s_lshl_b32 s93, s3, 15
    s_and_b32 s50, s4, 7
    s_lshl_b32 s50, s50, 7
    s_add_u32 s93, s93, s50
    s_lshl_b32 s51, s3, 12
    s_add_u32 m0, s51, 98304
    s_add_u32 s50, s93, 0
    buffer_load_dwordx4 v224, s[36:39], s50 offen lds
    v_exp_f32 v26, v26
    v_exp_f32 v27, v27
    v_exp_f32 v28, v28
    v_exp_f32 v29, v29
    v_exp_f32 v30, v30
    v_exp_f32 v31, v31
    v_exp_f32 v32, v32
    v_exp_f32 v33, v33
    v_smfmac_f32_32x32x32_bf16 v[48:63], v[104:107], v[24:31], v2
    s_mov_b64 exec, s[44:45]
    s_waitcnt lgkmcnt(0)
    ds_read_b128 v[96:99], v4 offset:4096
    ds_read_b128 v[104:107], v4 offset:4608
    s_mov_b64 exec, -1
    ds_read_b128 v[92:95], v3 offset:5120
    v_exp_f32 v34, v34
    v_exp_f32 v35, v35
    v_exp_f32 v36, v36
    v_mfma_f32_32x32x16_bf16 v[16:31], v[88:91], v[80:83], v[64:79]
    v_exp_f32 v37, v37
    v_exp_f32 v38, v38
    v_exp_f32 v39, v39
    v_exp_f32 v40, v40
    v_exp_f32 v41, v41
    v_smfmac_f32_32x32x32_bf16 v[48:63], v[100:103], v[32:39], v2
    s_lshl_b32 s51, s3, 12
    s_add_u32 m0, s51, 99328
    s_add_u32 s50, s93, 8192
    buffer_load_dwordx4 v224, s[36:39], s50 offen lds
    v_exp_f32 v42, v42
    v_exp_f32 v43, v43
    v_exp_f32 v44, v44
    v_exp_f32 v45, v45
    v_exp_f32 v46, v46
    v_exp_f32 v47, v47
    v_exp_f32 v16, v16
    v_exp_f32 v17, v17
    v_smfmac_f32_32x32x32_bf16 v[48:63], v[108:111], v[40:47], v2
    s_mov_b64 exec, s[44:45]
    s_waitcnt lgkmcnt(0)
    ds_read_b128 v[100:103], v4 offset:5120
    ds_read_b128 v[108:111], v4 offset:5632
    s_mov_b64 exec, -1
    ds_read_b128 v[88:91], v3 offset:6144
    v_exp_f32 v18, v18
    v_exp_f32 v19, v19
    v_exp_f32 v20, v20
    v_mfma_f32_32x32x16_bf16 v[32:47], v[92:95], v[80:83], v[64:79]
    v_exp_f32 v21, v21
    s_lshr_b32 s51, s4, 3
    s_lshl1_add_u32 s50, s51, s99
    s_lshl2_add_u32 s50, s5, s50
    s_lshl_b32 s50, s50, 15
    s_lshl_b32 s51, s6, 12
    s_add_u32 s50, s50, s51
    s_add_u32 s50, s50, 5242880
    s_lshr_b32 s51, s4, 3
    s_lshl_b32 s51, s51, 14
    s_add_u32 s77, s50, s51
    s_sub_u32 s50, s50, s51
    s_add_u32 s76, s50, 16384
    buffer_load_dwordx4 v[112:115], v6, s[24:27], s76 offen offset:0 sc1
    v_exp_f32 v22, v22
    v_exp_f32 v23, v23
    v_exp_f32 v24, v24
    v_exp_f32 v25, v25
    v_smfmac_f32_32x32x32_bf16 v[48:63], v[96:99], v[16:23], v2
    s_lshl_b32 s51, s3, 12
    s_add_u32 m0, s51, 100352
    s_add_u32 s50, s93, 16384
    buffer_load_dwordx4 v224, s[36:39], s50 offen lds
    v_exp_f32 v26, v26
    v_exp_f32 v27, v27
    v_exp_f32 v28, v28
    buffer_load_dwordx4 v[116:119], v6, s[24:27], s76 offen offset:1024 sc1
    v_exp_f32 v29, v29
    v_exp_f32 v30, v30
    v_exp_f32 v31, v31
    v_exp_f32 v32, v32
    v_exp_f32 v33, v33
    v_smfmac_f32_32x32x32_bf16 v[48:63], v[104:107], v[24:31], v2
    s_mov_b64 exec, s[44:45]
    s_waitcnt lgkmcnt(0)
    ds_read_b128 v[96:99], v4 offset:6144
    ds_read_b128 v[104:107], v4 offset:6656
    s_mov_b64 exec, -1
    ds_read_b128 v[92:95], v3 offset:7168
    v_exp_f32 v34, v34
    v_exp_f32 v35, v35
    v_exp_f32 v36, v36
    v_mfma_f32_32x32x16_bf16 v[16:31], v[88:91], v[80:83], v[64:79]
    v_exp_f32 v37, v37
    buffer_load_dwordx4 v[120:123], v6, s[24:27], s76 offen offset:2048 sc1
    v_exp_f32 v38, v38
    v_exp_f32 v39, v39
    v_exp_f32 v40, v40
    v_exp_f32 v41, v41
    v_smfmac_f32_32x32x32_bf16 v[48:63], v[100:103], v[32:39], v2
    s_setprio 2
    s_lshl_b32 s51, s3, 12
    s_add_u32 m0, s51, 101376
    s_add_u32 s50, s93, 24576
    buffer_load_dwordx4 v224, s[36:39], s50 offen lds
    v_exp_f32 v42, v42
    v_exp_f32 v43, v43
    v_exp_f32 v44, v44
    buffer_load_dwordx4 v[124:127], v6, s[24:27], s76 offen offset:3072 sc1
    v_exp_f32 v45, v45
    v_exp_f32 v46, v46
    v_exp_f32 v47, v47
    v_add_u32 v3, 4294836224, v3
    v_exp_f32 v16, v16
    v_exp_f32 v17, v17
    v_smfmac_f32_32x32x32_bf16 v[48:63], v[108:111], v[40:47], v2
    s_mov_b64 exec, s[44:45]
    s_waitcnt lgkmcnt(0)
    ds_read_b128 v[100:103], v4 offset:7168
    ds_read_b128 v[108:111], v4 offset:7680
    s_mov_b64 exec, -1
    ds_read_b128 v[88:91], v3 offset:0
    v_exp_f32 v18, v18
    v_exp_f32 v19, v19
    v_exp_f32 v20, v20
    v_mfma_f32_32x32x16_bf16 v[32:47], v[92:95], v[80:83], v[64:79]
    v_exp_f32 v21, v21
    buffer_load_dwordx4 v[128:131], v6, s[24:27], s77 offen offset:0 sc1
    v_exp_f32 v22, v22
    v_exp_f32 v23, v23
    v_exp_f32 v24, v24
    v_exp_f32 v25, v25
    v_smfmac_f32_32x32x32_bf16 v[48:63], v[96:99], v[16:23], v2
    v_exp_f32 v26, v26
    v_exp_f32 v27, v27
    v_exp_f32 v28, v28
    buffer_load_dwordx4 v[132:135], v6, s[24:27], s77 offen offset:1024 sc1
    v_exp_f32 v29, v29
    v_exp_f32 v30, v30
    v_exp_f32 v31, v31
    v_add_u32 v4, 4294836224, v4
    v_exp_f32 v32, v32
    v_exp_f32 v33, v33
    v_smfmac_f32_32x32x32_bf16 v[48:63], v[104:107], v[24:31], v2
    s_mov_b64 exec, s[44:45]
    s_waitcnt lgkmcnt(0)
    ds_read_b128 v[96:99], v4 offset:0
    ds_read_b128 v[104:107], v4 offset:512
    s_mov_b64 exec, -1
    ds_read_b128 v[92:95], v3 offset:1024
    v_exp_f32 v34, v34
    v_exp_f32 v35, v35
    v_exp_f32 v36, v36
    v_mfma_f32_32x32x16_bf16 v[16:31], v[88:91], v[80:83], v[64:79]
    v_exp_f32 v37, v37
    buffer_load_dwordx4 v[136:139], v6, s[24:27], s77 offen offset:2048 sc1
    v_exp_f32 v38, v38
    v_exp_f32 v39, v39
    v_exp_f32 v40, v40
    v_exp_f32 v41, v41
    v_smfmac_f32_32x32x32_bf16 v[48:63], v[100:103], v[32:39], v2
    v_exp_f32 v42, v42
    v_exp_f32 v43, v43
    v_exp_f32 v44, v44
    buffer_load_dwordx4 v[140:143], v6, s[24:27], s77 offen offset:3072 sc1
    v_exp_f32 v45, v45
    v_exp_f32 v46, v46
    v_exp_f32 v47, v47
    v_exp_f32 v16, v16
    v_exp_f32 v17, v17
    v_smfmac_f32_32x32x32_bf16 v[48:63], v[108:111], v[40:47], v2
    s_mov_b64 exec, s[44:45]
    s_waitcnt lgkmcnt(0)
    ds_read_b128 v[100:103], v4 offset:1024
    ds_read_b128 v[108:111], v4 offset:1536
    s_mov_b64 exec, -1
    ds_read_b128 v[88:91], v3 offset:2048
    v_exp_f32 v18, v18
    v_exp_f32 v19, v19
    v_exp_f32 v20, v20
    v_mfma_f32_32x32x16_bf16 v[32:47], v[92:95], v[80:83], v[64:79]
    v_exp_f32 v21, v21
    v_exp_f32 v22, v22
    v_exp_f32 v23, v23
    v_exp_f32 v24, v24
    v_exp_f32 v25, v25
    v_smfmac_f32_32x32x32_bf16 v[48:63], v[96:99], v[16:23], v2
    s_setprio 1
    v_exp_f32 v26, v26
    v_exp_f32 v27, v27
    v_exp_f32 v28, v28
    v_exp_f32 v29, v29
    v_exp_f32 v30, v30
    v_exp_f32 v31, v31
    v_exp_f32 v32, v32
    v_exp_f32 v33, v33
    v_smfmac_f32_32x32x32_bf16 v[48:63], v[104:107], v[24:31], v2
    s_mov_b64 exec, s[44:45]
    s_waitcnt lgkmcnt(0)
    ds_read_b128 v[96:99], v4 offset:2048
    ds_read_b128 v[104:107], v4 offset:2560
    s_mov_b64 exec, -1
    ds_read_b128 v[92:95], v3 offset:3072
    v_exp_f32 v34, v34
    v_exp_f32 v35, v35
    v_exp_f32 v36, v36
    v_mfma_f32_32x32x16_bf16 v[16:31], v[88:91], v[80:83], v[64:79]
    s_setprio 0
    v_exp_f32 v37, v37
    v_exp_f32 v38, v38
    v_exp_f32 v39, v39
    v_exp_f32 v40, v40
    v_exp_f32 v41, v41
    v_smfmac_f32_32x32x32_bf16 v[48:63], v[100:103], v[32:39], v2
    s_waitcnt vmcnt(12)
    s_barrier
    v_exp_f32 v42, v42
    v_exp_f32 v43, v43
    v_exp_f32 v44, v44
    v_exp_f32 v45, v45
    v_exp_f32 v46, v46
    v_exp_f32 v47, v47
    v_exp_f32 v16, v16
    v_exp_f32 v17, v17
    v_smfmac_f32_32x32x32_bf16 v[48:63], v[108:111], v[40:47], v2
    s_setprio 3
    s_mov_b64 exec, s[44:45]
    s_waitcnt lgkmcnt(0)
    ds_read_b128 v[100:103], v4 offset:3072
    ds_read_b128 v[108:111], v4 offset:3584
    s_mov_b64 exec, -1
    ds_read_b128 v[88:91], v3 offset:4096
    v_exp_f32 v18, v18
    v_exp_f32 v19, v19
    v_exp_f32 v20, v20
    v_mfma_f32_32x32x16_bf16 v[32:47], v[92:95], v[80:83], v[64:79]
    v_exp_f32 v21, v21
    v_exp_f32 v22, v22
    v_exp_f32 v23, v23
    v_exp_f32 v24, v24
    v_exp_f32 v25, v25
    v_smfmac_f32_32x32x32_bf16 v[48:63], v[96:99], v[16:23], v2
    s_lshl_b32 s93, s3, 15
    s_and_b32 s50, s4, 7
    s_lshl_b32 s50, s50, 7
    s_add_u32 s93, s93, s50
    s_lshl_b32 s51, s3, 12
    s_add_u32 m0, s51, 131072
    s_add_u32 s50, s93, 262144
    buffer_load_dwordx4 v224, s[36:39], s50 offen lds
    v_exp_f32 v26, v26
    v_exp_f32 v27, v27
    v_exp_f32 v28, v28
    v_exp_f32 v29, v29
    v_exp_f32 v30, v30
    v_exp_f32 v31, v31
    v_exp_f32 v32, v32
    v_exp_f32 v33, v33
    v_smfmac_f32_32x32x32_bf16 v[48:63], v[104:107], v[24:31], v2
    s_mov_b64 exec, s[44:45]
    s_waitcnt lgkmcnt(0)
    ds_read_b128 v[96:99], v4 offset:4096
    ds_read_b128 v[104:107], v4 offset:4608
    s_mov_b64 exec, -1
    ds_read_b128 v[92:95], v3 offset:5120
    v_exp_f32 v34, v34
    v_exp_f32 v35, v35
    v_exp_f32 v36, v36
    v_mfma_f32_32x32x16_bf16 v[16:31], v[88:91], v[80:83], v[64:79]
    v_exp_f32 v37, v37
    v_exp_f32 v38, v38
    v_exp_f32 v39, v39
    v_exp_f32 v40, v40
    v_exp_f32 v41, v41
    v_smfmac_f32_32x32x32_bf16 v[48:63], v[100:103], v[32:39], v2
    s_setprio 2
    s_lshl_b32 s51, s3, 12
    s_add_u32 m0, s51, 132096
    s_add_u32 s50, s93, 270336
    buffer_load_dwordx4 v224, s[36:39], s50 offen lds
    v_exp_f32 v42, v42
    v_exp_f32 v43, v43
    v_exp_f32 v44, v44
    v_exp_f32 v45, v45
    v_exp_f32 v46, v46
    v_exp_f32 v47, v47
    v_exp_f32 v16, v16
    v_exp_f32 v17, v17
    v_smfmac_f32_32x32x32_bf16 v[48:63], v[108:111], v[40:47], v2
    s_mov_b64 exec, s[44:45]
    s_waitcnt lgkmcnt(0)
    ds_read_b128 v[100:103], v4 offset:5120
    ds_read_b128 v[108:111], v4 offset:5632
    s_mov_b64 exec, -1
    ds_read_b128 v[88:91], v3 offset:6144
    v_exp_f32 v18, v18
    v_exp_f32 v19, v19
    v_exp_f32 v20, v20
    v_mfma_f32_32x32x16_bf16 v[32:47], v[92:95], v[80:83], v[64:79]
    v_exp_f32 v21, v21
    v_exp_f32 v22, v22
    v_exp_f32 v23, v23
    v_exp_f32 v24, v24
    v_exp_f32 v25, v25
    v_smfmac_f32_32x32x32_bf16 v[48:63], v[96:99], v[16:23], v2
    s_lshl_b32 s51, s3, 12
    s_add_u32 m0, s51, 133120
    s_add_u32 s50, s93, 278528
    buffer_load_dwordx4 v224, s[36:39], s50 offen lds
    v_exp_f32 v26, v26
    v_exp_f32 v27, v27
    v_exp_f32 v28, v28
    v_exp_f32 v29, v29
    v_exp_f32 v30, v30
    v_exp_f32 v31, v31
    v_exp_f32 v32, v32
    v_exp_f32 v33, v33
    v_smfmac_f32_32x32x32_bf16 v[48:63], v[104:107], v[24:31], v2
    s_mov_b64 exec, s[44:45]
    s_waitcnt lgkmcnt(0)
    ds_read_b128 v[96:99], v4 offset:6144
    ds_read_b128 v[104:107], v4 offset:6656
    s_mov_b64 exec, -1
    ds_read_b128 v[92:95], v3 offset:7168
    v_exp_f32 v34, v34
    v_exp_f32 v35, v35
    v_exp_f32 v36, v36
    v_mfma_f32_32x32x16_bf16 v[16:31], v[88:91], v[80:83], v[64:79]
    v_exp_f32 v37, v37
    v_exp_f32 v38, v38
    v_exp_f32 v39, v39
    v_exp_f32 v40, v40
    v_exp_f32 v41, v41
    v_smfmac_f32_32x32x32_bf16 v[48:63], v[100:103], v[32:39], v2
    s_setprio 1
    s_lshl_b32 s51, s3, 12
    s_add_u32 m0, s51, 134144
    s_add_u32 s50, s93, 286720
    buffer_load_dwordx4 v224, s[36:39], s50 offen lds
    v_exp_f32 v42, v42
    v_exp_f32 v43, v43
    v_exp_f32 v44, v44
    v_exp_f32 v45, v45
    v_exp_f32 v46, v46
    v_exp_f32 v47, v47
    v_exp_f32 v16, v16
    v_exp_f32 v17, v17
    v_smfmac_f32_32x32x32_bf16 v[48:63], v[108:111], v[40:47], v2
    s_mov_b64 exec, s[44:45]
    s_waitcnt lgkmcnt(0)
    ds_read_b128 v[100:103], v4 offset:7168
    ds_read_b128 v[108:111], v4 offset:7680
    s_mov_b64 exec, -1
    v_exp_f32 v18, v18
    v_exp_f32 v19, v19
    v_exp_f32 v20, v20
    v_mfma_f32_32x32x16_bf16 v[32:47], v[92:95], v[80:83], v[64:79]
    v_exp_f32 v21, v21
    v_exp_f32 v22, v22
    v_exp_f32 v23, v23
    v_exp_f32 v24, v24
    v_exp_f32 v25, v25
    v_smfmac_f32_32x32x32_bf16 v[48:63], v[96:99], v[16:23], v2
    v_exp_f32 v26, v26
    v_exp_f32 v27, v27
    v_exp_f32 v28, v28
    v_exp_f32 v29, v29
    v_exp_f32 v30, v30
    v_exp_f32 v31, v31
    v_exp_f32 v32, v32
    v_exp_f32 v33, v33
    v_smfmac_f32_32x32x32_bf16 v[48:63], v[104:107], v[24:31], v2
    s_setprio 0
    s_waitcnt lgkmcnt(0)
    v_exp_f32 v34, v34
    v_exp_f32 v35, v35
    v_exp_f32 v36, v36
    v_exp_f32 v37, v37
    v_exp_f32 v38, v38
    v_exp_f32 v39, v39
    v_exp_f32 v40, v40
    v_exp_f32 v41, v41
    v_smfmac_f32_32x32x32_bf16 v[48:63], v[100:103], v[32:39], v2
    v_exp_f32 v42, v42
    v_exp_f32 v43, v43
    v_exp_f32 v44, v44
    v_exp_f32 v45, v45
    v_exp_f32 v46, v46
    v_exp_f32 v47, v47
    s_nop 1
    v_smfmac_f32_32x32x32_bf16 v[48:63], v[108:111], v[40:47], v2
    ds_read_b64_tr_b16 v[16:17], v228 offset:0
    ds_read_b64_tr_b16 v[18:19], v228 offset:1024
    ds_read_b64_tr_b16 v[20:21], v229 offset:0
    ds_read_b64_tr_b16 v[22:23], v229 offset:1024
    ds_read_b64_tr_b16 v[24:25], v228 offset:2048
    ds_read_b64_tr_b16 v[26:27], v228 offset:3072
    ds_read_b64_tr_b16 v[28:29], v229 offset:2048
    ds_read_b64_tr_b16 v[30:31], v229 offset:3072
    ds_read_b64_tr_b16 v[32:33], v228 offset:4096
    ds_read_b64_tr_b16 v[34:35], v228 offset:5120
    ds_read_b64_tr_b16 v[36:37], v229 offset:4096
    ds_read_b64_tr_b16 v[38:39], v229 offset:5120
    v_mov_b32 v8, v56
    v_add_f32 v10, |v48|, |v49|
    v_add_f32 v10, v10, |v50|
    v_add_f32 v10, v10, |v51|
    v_add_f32 v10, v10, |v52|
    v_add_f32 v10, v10, |v53|
    v_add_f32 v10, v10, |v54|
    v_add_f32 v10, v10, |v55|
    v_permlane32_swap_b32 v8, v56
    v_subrev_u32 v10, 142606336, v10
    s_mov_b32 s50, 1929379840
    s_nop 0
    v_subrev_u32 v11, 142606336, v8
    v_max_u32 v10, v10, v11
    v_cmp_le_u32 vcc, s50, v10
    s_nop 0
    s_cbranch_vccnz L_fallback1
L_fbret1:
    v_rcp_f32 v8, v8
    s_lshr_b32 s51, s4, 3
    s_lshl1_add_u32 s50, s51, s99
    s_lshl2_add_u32 s50, s5, s50
    s_lshl_b32 s50, s50, 15
    s_lshl_b32 s51, s6, 12
    s_add_u32 s50, s50, s51
    s_add_u32 s50, s50, 7340032
    s_lshr_b32 s51, s4, 3
    s_lshl_b32 s51, s51, 14
    s_add_u32 s77, s50, s51
    s_sub_u32 s50, s50, s51
    s_add_u32 s76, s50, 16384
    v_mul_f32 v8, v8, v5
    v_pk_mul_f32 v[48:49], v[48:49], v[8:9] op_sel_hi:[1,0]
    v_pk_mul_f32 v[50:51], v[50:51], v[8:9] op_sel_hi:[1,0]
    v_pk_mul_f32 v[52:53], v[52:53], v[8:9] op_sel_hi:[1,0]
    v_pk_mul_f32 v[54:55], v[54:55], v[8:9] op_sel_hi:[1,0]
    v_cvt_pk_bf16_f32 v12, v48, v49
    v_cvt_pk_bf16_f32 v13, v50, v51
    v_cvt_pk_bf16_f32 v14, v52, v53
    v_cvt_pk_bf16_f32 v15, v54, v55
    v_min_u32 v12, -2, v12
    v_min_u32 v13, -2, v13
    v_min_u32 v14, -2, v14
    v_min_u32 v15, -2, v15
    s_add_u32 s50, s90, 7340032
    buffer_store_dwordx4 v[12:15], v6, s[24:27], s50 offen sc1
    s_waitcnt vmcnt(5)
    s_waitcnt vmcnt(1)
    s_barrier
    s_waitcnt lgkmcnt(8)
    v_mfma_f32_32x32x16_bf16 v[144:159], v[16:19], v[112:115], 0
    v_mfma_f32_32x32x16_bf16 v[160:175], v[20:23], v[112:115], 0
    ds_read_b64_tr_b16 v[40:41], v228 offset:6144
    ds_read_b64_tr_b16 v[42:43], v228 offset:7168
    ds_read_b64_tr_b16 v[44:45], v229 offset:6144
    ds_read_b64_tr_b16 v[46:47], v229 offset:7168
    s_waitcnt lgkmcnt(8)
    v_mfma_f32_32x32x16_bf16 v[144:159], v[24:27], v[116:119], v[144:159]
    v_mfma_f32_32x32x16_bf16 v[160:175], v[28:31], v[116:119], v[160:175]
    ds_read_b64_tr_b16 v[48:49], v230 offset:0
    ds_read_b64_tr_b16 v[50:51], v230 offset:1024
    ds_read_b64_tr_b16 v[52:53], v231 offset:0
    ds_read_b64_tr_b16 v[54:55], v231 offset:1024
    v_add_u32 v228, 65536, v228
    v_add_u32 v229, 65536, v229
    s_waitcnt lgkmcnt(8)
    v_mfma_f32_32x32x16_bf16 v[144:159], v[32:35], v[120:123], v[144:159]
    v_mfma_f32_32x32x16_bf16 v[160:175], v[36:39], v[120:123], v[160:175]
    ds_read_b64_tr_b16 v[56:57], v230 offset:2048
    ds_read_b64_tr_b16 v[58:59], v230 offset:3072
    ds_read_b64_tr_b16 v[60:61], v231 offset:2048
    ds_read_b64_tr_b16 v[62:63], v231 offset:3072
    s_waitcnt lgkmcnt(8)
    v_mfma_f32_32x32x16_bf16 v[144:159], v[40:43], v[124:127], v[144:159]
    v_mfma_f32_32x32x16_bf16 v[160:175], v[44:47], v[124:127], v[160:175]
    ds_read_b64_tr_b16 v[64:65], v230 offset:4096
    ds_read_b64_tr_b16 v[66:67], v230 offset:5120
    ds_read_b64_tr_b16 v[68:69], v231 offset:4096
    ds_read_b64_tr_b16 v[70:71], v231 offset:5120
    s_waitcnt lgkmcnt(8)
    v_mfma_f32_32x32x16_bf16 v[144:159], v[48:51], v[128:131], v[144:159]
    v_mfma_f32_32x32x16_bf16 v[160:175], v[52:55], v[128:131], v[160:175]
    ds_read_b64_tr_b16 v[72:73], v230 offset:6144
    ds_read_b64_tr_b16 v[74:75], v230 offset:7168
    ds_read_b64_tr_b16 v[76:77], v231 offset:6144
    ds_read_b64_tr_b16 v[78:79], v231 offset:7168
    s_waitcnt lgkmcnt(8)
    v_mfma_f32_32x32x16_bf16 v[144:159], v[56:59], v[132:135], v[144:159]
    v_mfma_f32_32x32x16_bf16 v[160:175], v[60:63], v[132:135], v[160:175]
    ds_read_b64_tr_b16 v[16:17], v228 offset:0
    ds_read_b64_tr_b16 v[18:19], v228 offset:1024
    ds_read_b64_tr_b16 v[20:21], v229 offset:0
    ds_read_b64_tr_b16 v[22:23], v229 offset:1024
    v_add_u32 v230, 65536, v230
    v_add_u32 v231, 65536, v231
    s_waitcnt lgkmcnt(8)
    v_mfma_f32_32x32x16_bf16 v[144:159], v[64:67], v[136:139], v[144:159]
    v_mfma_f32_32x32x16_bf16 v[160:175], v[68:71], v[136:139], v[160:175]
    ds_read_b64_tr_b16 v[24:25], v228 offset:2048
    ds_read_b64_tr_b16 v[26:27], v228 offset:3072
    ds_read_b64_tr_b16 v[28:29], v229 offset:2048
    ds_read_b64_tr_b16 v[30:31], v229 offset:3072
    s_waitcnt lgkmcnt(8)
    v_mfma_f32_32x32x16_bf16 v[144:159], v[72:75], v[140:143], v[144:159]
    v_mfma_f32_32x32x16_bf16 v[160:175], v[76:79], v[140:143], v[160:175]
    ds_read_b64_tr_b16 v[32:33], v228 offset:4096
    ds_read_b64_tr_b16 v[34:35], v228 offset:5120
    ds_read_b64_tr_b16 v[36:37], v229 offset:4096
    ds_read_b64_tr_b16 v[38:39], v229 offset:5120
    s_waitcnt lgkmcnt(8)
    ds_read_b64_tr_b16 v[40:41], v228 offset:6144
    ds_read_b64_tr_b16 v[42:43], v228 offset:7168
    ds_read_b64_tr_b16 v[44:45], v229 offset:6144
    ds_read_b64_tr_b16 v[46:47], v229 offset:7168
    buffer_load_dwordx4 v[176:179], v6, s[24:27], s76 offen offset:0 sc1
    buffer_load_dwordx4 v[180:183], v6, s[24:27], s76 offen offset:1024 sc1
    buffer_load_dwordx4 v[184:187], v6, s[24:27], s76 offen offset:2048 sc1
    buffer_load_dwordx4 v[188:191], v6, s[24:27], s76 offen offset:3072 sc1
    s_waitcnt lgkmcnt(8)
    ds_read_b64_tr_b16 v[48:49], v230 offset:0
    ds_read_b64_tr_b16 v[50:51], v230 offset:1024
    ds_read_b64_tr_b16 v[52:53], v231 offset:0
    ds_read_b64_tr_b16 v[54:55], v231 offset:1024
    buffer_load_dwordx4 v[192:195], v6, s[24:27], s77 offen offset:0 sc1
    buffer_load_dwordx4 v[196:199], v6, s[24:27], s77 offen offset:1024 sc1
    s_waitcnt lgkmcnt(8)
    ds_read_b64_tr_b16 v[56:57], v230 offset:2048
    ds_read_b64_tr_b16 v[58:59], v230 offset:3072
    ds_read_b64_tr_b16 v[60:61], v231 offset:2048
    ds_read_b64_tr_b16 v[62:63], v231 offset:3072
    buffer_load_dwordx4 v[200:203], v6, s[24:27], s77 offen offset:2048 sc1
    buffer_load_dwordx4 v[204:207], v6, s[24:27], s77 offen offset:3072 sc1
    s_waitcnt lgkmcnt(8)
    ds_read_b64_tr_b16 v[64:65], v230 offset:4096
    ds_read_b64_tr_b16 v[66:67], v230 offset:5120
    ds_read_b64_tr_b16 v[68:69], v231 offset:4096
    ds_read_b64_tr_b16 v[70:71], v231 offset:5120
    s_waitcnt lgkmcnt(8)
    ds_read_b64_tr_b16 v[72:73], v230 offset:6144
    ds_read_b64_tr_b16 v[74:75], v230 offset:7168
    ds_read_b64_tr_b16 v[76:77], v231 offset:6144
    ds_read_b64_tr_b16 v[78:79], v231 offset:7168
    v_and_b32 v8, 31, v1
    v_lshrrev_b32 v9, 5, v1
    v_and_b32 v10, 15, v1
    v_xor_b32 v9, v9, v10
    v_lshlrev_b32 v9, 4, v9
    v_lshl_add_u32 v8, v8, 8, v9
    s_lshl_b32 s50, s3, 13
    v_add_u32 v80, s50, v8
    v_lshrrev_b32 v8, 3, v1
    s_lshl_b32 s50, s6, 3
    v_add_u32 v8, s50, v8
    v_and_b32 v9, 7, v1
    v_lshlrev_b32 v10, 1, v9
    v_and_b32 v11, 15, v8
    v_xor_b32 v10, v10, v11
    v_lshlrev_b32 v10, 4, v10
    v_lshl_add_u32 v10, v8, 8, v10
    s_lshl_b32 s50, s99, 15
    v_add_u32 v88, s50, v10
    v_xor_b32 v89, 16, v88
    s_lshr_b32 s51, s4, 3
    s_lshl1_add_u32 s50, s51, s99
    s_lshl2_add_u32 s50, s5, s50
    s_lshl_b32 s50, s50, 5
    v_add_u32 v8, s50, v8
    v_lshlrev_b32 v8, 10, v8
    v_lshl_add_u32 v8, v9, 4, v8
    s_and_b32 s51, s4, 7
    s_lshl_b32 s51, s51, 7
    v_add_u32 v226, s51, v8
    v_xor_b32 v81, 32, v80
    v_xor_b32 v82, 64, v80
    v_xor_b32 v83, 96, v80
    v_xor_b32 v84, 128, v80
    v_xor_b32 v85, 160, v80
    v_xor_b32 v86, 192, v80
    v_xor_b32 v87, 224, v80
    s_waitcnt lgkmcnt(0)
    s_barrier
    s_mov_b32 s93, 0
    s_waitcnt vmcnt(4)
    v_max3_u32 v8, v176, v177, v178
    v_max3_u32 v9, v179, v180, v181
    v_max3_u32 v8, v8, v182, v183
    v_max3_u32 v9, v9, v184, v185
    v_max3_u32 v8, v8, v186, v187
    v_max3_u32 v9, v9, v188, v189
    v_max3_u32 v8, v8, v190, v191
    v_max_u32 v8, v8, v9
    v_cmp_eq_u32 vcc, -1, v8
    s_nop 0
    s_cbranch_vccnz L_ob_66
    v_mfma_f32_32x32x16_bf16 v[144:159], v[16:19], v[176:179], v[144:159]
    v_mfma_f32_32x32x16_bf16 v[144:159], v[24:27], v[180:183], v[144:159]
    v_mfma_f32_32x32x16_bf16 v[144:159], v[32:35], v[184:187], v[144:159]
    v_mfma_f32_32x32x16_bf16 v[144:159], v[40:43], v[188:191], v[144:159]
    v_mfma_f32_32x32x16_bf16 v[160:175], v[20:23], v[176:179], v[160:175]
    v_mfma_f32_32x32x16_bf16 v[160:175], v[28:31], v[180:183], v[160:175]
    v_mfma_f32_32x32x16_bf16 v[160:175], v[36:39], v[184:187], v[160:175]
    v_mfma_f32_32x32x16_bf16 v[160:175], v[44:47], v[188:191], v[160:175]
    s_branch L_oa_65
L_ob_66:
    s_bitset1_b32 s93, 0
L_oa_65:
    s_waitcnt vmcnt(0)
    v_max3_u32 v8, v192, v193, v194
    v_max3_u32 v9, v195, v196, v197
    v_max3_u32 v8, v8, v198, v199
    v_max3_u32 v9, v9, v200, v201
    v_max3_u32 v8, v8, v202, v203
    v_max3_u32 v9, v9, v204, v205
    v_max3_u32 v8, v8, v206, v207
    v_max_u32 v8, v8, v9
    v_cmp_eq_u32 vcc, -1, v8
    s_nop 0
    s_cbranch_vccnz L_ob_68
    v_mfma_f32_32x32x16_bf16 v[144:159], v[48:51], v[192:195], v[144:159]
    v_mfma_f32_32x32x16_bf16 v[144:159], v[56:59], v[196:199], v[144:159]
    v_mfma_f32_32x32x16_bf16 v[144:159], v[64:67], v[200:203], v[144:159]
    v_mfma_f32_32x32x16_bf16 v[144:159], v[72:75], v[204:207], v[144:159]
    v_mfma_f32_32x32x16_bf16 v[160:175], v[52:55], v[192:195], v[160:175]
    v_mfma_f32_32x32x16_bf16 v[160:175], v[60:63], v[196:199], v[160:175]
    v_mfma_f32_32x32x16_bf16 v[160:175], v[68:71], v[200:203], v[160:175]
    v_mfma_f32_32x32x16_bf16 v[160:175], v[76:79], v[204:207], v[160:175]
    s_branch L_oa_67
L_ob_68:
    s_bitset1_b32 s93, 1
L_oa_67:
L_oa_loop:
    s_cmp_eq_u32 s93, 0
    s_cbranch_scc1 L_oa_done
    s_sub_u32 s48, s48, 1
    s_cbranch_scc1 L_abort
    s_bitcmp1_b32 s93, 0
    s_cbranch_scc0 L_oc_69
    buffer_load_dwordx4 v[176:179], v6, s[24:27], s76 offen offset:0 sc1
    buffer_load_dwordx4 v[180:183], v6, s[24:27], s76 offen offset:1024 sc1
    buffer_load_dwordx4 v[184:187], v6, s[24:27], s76 offen offset:2048 sc1
    buffer_load_dwordx4 v[188:191], v6, s[24:27], s76 offen offset:3072 sc1
L_oc_69:
    s_bitcmp1_b32 s93, 1
    s_cbranch_scc0 L_oc_70
    buffer_load_dwordx4 v[192:195], v6, s[24:27], s77 offen offset:0 sc1
    buffer_load_dwordx4 v[196:199], v6, s[24:27], s77 offen offset:1024 sc1
    buffer_load_dwordx4 v[200:203], v6, s[24:27], s77 offen offset:2048 sc1
    buffer_load_dwordx4 v[204:207], v6, s[24:27], s77 offen offset:3072 sc1
L_oc_70:
    s_waitcnt vmcnt(0)
    s_bitcmp1_b32 s93, 0
    s_cbranch_scc0 L_od_71
    v_max3_u32 v8, v176, v177, v178
    v_max3_u32 v9, v179, v180, v181
    v_max3_u32 v8, v8, v182, v183
    v_max3_u32 v9, v9, v184, v185
    v_max3_u32 v8, v8, v186, v187
    v_max3_u32 v9, v9, v188, v189
    v_max3_u32 v8, v8, v190, v191
    v_max_u32 v8, v8, v9
    v_cmp_eq_u32 vcc, -1, v8
    s_nop 0
    s_cbranch_vccnz L_od_71
    v_mfma_f32_32x32x16_bf16 v[144:159], v[16:19], v[176:179], v[144:159]
    v_mfma_f32_32x32x16_bf16 v[144:159], v[24:27], v[180:183], v[144:159]
    v_mfma_f32_32x32x16_bf16 v[144:159], v[32:35], v[184:187], v[144:159]
    v_mfma_f32_32x32x16_bf16 v[144:159], v[40:43], v[188:191], v[144:159]
    v_mfma_f32_32x32x16_bf16 v[160:175], v[20:23], v[176:179], v[160:175]
    v_mfma_f32_32x32x16_bf16 v[160:175], v[28:31], v[180:183], v[160:175]
    v_mfma_f32_32x32x16_bf16 v[160:175], v[36:39], v[184:187], v[160:175]
    v_mfma_f32_32x32x16_bf16 v[160:175], v[44:47], v[188:191], v[160:175]
    s_bitset0_b32 s93, 0
L_od_71:
    s_bitcmp1_b32 s93, 1
    s_cbranch_scc0 L_od_72
    v_max3_u32 v8, v192, v193, v194
    v_max3_u32 v9, v195, v196, v197
    v_max3_u32 v8, v8, v198, v199
    v_max3_u32 v9, v9, v200, v201
    v_max3_u32 v8, v8, v202, v203
    v_max3_u32 v9, v9, v204, v205
    v_max3_u32 v8, v8, v206, v207
    v_max_u32 v8, v8, v9
    v_cmp_eq_u32 vcc, -1, v8
    s_nop 0
    s_cbranch_vccnz L_od_72
    v_mfma_f32_32x32x16_bf16 v[144:159], v[48:51], v[192:195], v[144:159]
    v_mfma_f32_32x32x16_bf16 v[144:159], v[56:59], v[196:199], v[144:159]
    v_mfma_f32_32x32x16_bf16 v[144:159], v[64:67], v[200:203], v[144:159]
    v_mfma_f32_32x32x16_bf16 v[144:159], v[72:75], v[204:207], v[144:159]
    v_mfma_f32_32x32x16_bf16 v[160:175], v[52:55], v[192:195], v[160:175]
    v_mfma_f32_32x32x16_bf16 v[160:175], v[60:63], v[196:199], v[160:175]
    v_mfma_f32_32x32x16_bf16 v[160:175], v[68:71], v[200:203], v[160:175]
    v_mfma_f32_32x32x16_bf16 v[160:175], v[76:79], v[204:207], v[160:175]
    s_bitset0_b32 s93, 1
L_od_72:
    s_branch L_oa_loop
L_oa_done:
    s_nop 5
    ds_write_b128 v80, v[144:147]
    ds_write_b128 v81, v[148:151]
    ds_write_b128 v82, v[152:155]
    ds_write_b128 v83, v[156:159]
    s_nop 1
    ds_write_b128 v84, v[160:163]
    ds_write_b128 v85, v[164:167]
    ds_write_b128 v86, v[168:171]
    ds_write_b128 v87, v[172:175]
    s_waitcnt lgkmcnt(0)
    s_barrier
    ds_read_b128 v[16:19], v88 offset:0
    ds_read_b128 v[20:23], v89 offset:0
    ds_read_b128 v[24:27], v88 offset:8192
    ds_read_b128 v[28:31], v89 offset:8192
    ds_read_b128 v[32:35], v88 offset:16384
    ds_read_b128 v[36:39], v89 offset:16384
    ds_read_b128 v[40:43], v88 offset:24576
    ds_read_b128 v[44:47], v89 offset:24576
    s_waitcnt lgkmcnt(4)
    v_pk_add_f32 v[16:17], v[16:17], v[24:25]
    v_pk_add_f32 v[18:19], v[18:19], v[26:27]
    v_pk_add_f32 v[20:21], v[20:21], v[28:29]
    v_pk_add_f32 v[22:23], v[22:23], v[30:31]
    s_waitcnt lgkmcnt(0)
    v_pk_add_f32 v[32:33], v[32:33], v[40:41]
    v_pk_add_f32 v[34:35], v[34:35], v[42:43]
    v_pk_add_f32 v[36:37], v[36:37], v[44:45]
    v_pk_add_f32 v[38:39], v[38:39], v[46:47]
    v_pk_add_f32 v[16:17], v[16:17], v[32:33]
    v_pk_add_f32 v[18:19], v[18:19], v[34:35]
    v_pk_add_f32 v[20:21], v[20:21], v[36:37]
    v_pk_add_f32 v[22:23], v[22:23], v[38:39]
    v_cvt_pk_bf16_f32 v16, v16, v17
    v_cvt_pk_bf16_f32 v17, v18, v19
    v_cvt_pk_bf16_f32 v18, v20, v21
    v_cvt_pk_bf16_f32 v19, v22, v23
    buffer_store_dwordx4 v[16:19], v226, s[32:35], 0 offen nt
L_abort:
    s_endpgm
L_rare_49:
    s_lshl_b32 s50, s4, 7
    s_lshl_b32 s51, s5, 2
    s_add_u32 s50, s50, s51
    s_add_u32 s50, s50, 4343808
    v_mov_b32 v8, s47
    v_mov_b32 v9, 0
    s_mov_b64 exec, 1
    buffer_store_dword v8, v9, s[24:27], s50 offen sc1
    s_mov_b64 exec, -1
    s_branch L_back_50
L_rare_51:
    v_and_b32 v8, 3, v1
    v_bfe_u32 v9, v1, 2, 1
    v_lshlrev_b32 v8, 4, v8
    v_lshl_add_u32 v250, v9, 7, v8
    s_and_b32 s92, s4, 14
    s_lshl_b32 s92, s92, 7
    s_add_u32 s92, s92, 4343808
    buffer_load_dwordx4 v[252:255], v250, s[24:27], s92 offen sc1
    s_branch L_back_52
L_rare_53:
L_pl_55:
    v_xor_b32 v252, s47, v252
    v_xor_b32 v253, s47, v253
    v_xor_b32 v254, s47, v254
    v_xor_b32 v255, s47, v255
    v_or_b32 v252, v252, v253
    v_or3_b32 v252, v252, v254, v255
    v_cmp_ne_u32 vcc, 0, v252
    s_nop 4
    s_cbranch_vccz L_pk_56
    s_sub_u32 s48, s48, 1
    s_cbranch_scc1 L_abort
    buffer_load_dwordx4 v[252:255], v250, s[24:27], s92 offen sc1
    s_waitcnt vmcnt(0)
    s_branch L_pl_55
L_pk_56:
    s_branch L_back_54
L_rare_57:
    s_lshl_b32 s50, s5, 7
    s_lshl_b32 s51, s4, 2
    s_add_u32 s50, s50, s51
    s_add_u32 s50, s50, 4345856
    v_mov_b32 v8, s47
    v_mov_b32 v9, 0
    s_mov_b64 exec, 1
    buffer_store_dword v8, v9, s[24:27], s50 offen sc1
    s_mov_b64 exec, -1
    s_branch L_back_58
L_rare_59:
    v_and_b32 v8, 3, v1
    v_lshlrev_b32 v250, 4, v8
    s_lshl_b32 s92, s5, 7
    s_add_u32 s92, s92, 4345856
    buffer_load_dwordx4 v[252:255], v250, s[24:27], s92 offen sc1
    s_branch L_back_60
L_rare_61:
L_pl_63:
    v_xor_b32 v252, s47, v252
    v_xor_b32 v253, s47, v253
    v_xor_b32 v254, s47, v254
    v_xor_b32 v255, s47, v255
    v_or_b32 v252, v252, v253
    v_or3_b32 v252, v252, v254, v255
    v_cmp_ne_u32 vcc, 0, v252
    s_nop 4
    s_cbranch_vccz L_pk_64
    s_sub_u32 s48, s48, 1
    s_cbranch_scc1 L_abort
    buffer_load_dwordx4 v[252:255], v250, s[24:27], s92 offen sc1
    s_waitcnt vmcnt(0)
    s_branch L_pl_63
L_pk_64:
    s_branch L_back_62
L_fallback0:
    s_mov_b32 s86, 4194304
    v_and_b32 v8, 31, v1
    v_cmp_eq_u32 vcc, 16, v8
    v_mov_b32 v9, 0x3f803f80
    s_nop 1
    v_cndmask_b32 v9, 0, v9, vcc
    v_mov_b32 v148, v9
    v_mov_b32 v149, v9
    v_mov_b32 v150, v9
    v_mov_b32 v151, v9
    v_mov_b32 v152, v9
    v_mov_b32 v153, v9
    v_mov_b32 v154, v9
    v_mov_b32 v155, v9
    v_mov_b32 v8, 0xff800000
    s_mov_b32 s88, 0
L_fb1_0:
    s_lshr_b32 s50, s88, 3
    s_lshl_b32 s50, s50, 14
    s_and_b32 s51, s88, 7
    s_lshl_b32 s51, s51, 10
    s_add_u32 s50, s50, s51
    s_add_u32 s50, s50, s86
    buffer_load_dwordx4 v[144:147], v6, s[24:27], s50 offen sc1
    s_waitcnt vmcnt(0)
    v_mfma_f32_32x32x16_bf16 v[176:191], v[144:147], v[84:87], 0
    s_nop 15
    v_max3_f32 v8, v8, v176, v177
    v_max3_f32 v8, v8, v178, v179
    v_max3_f32 v8, v8, v180, v181
    v_max3_f32 v8, v8, v182, v183
    v_max3_f32 v8, v8, v184, v185
    v_max3_f32 v8, v8, v186, v187
    v_max3_f32 v8, v8, v188, v189
    v_max3_f32 v8, v8, v190, v191
    s_add_u32 s88, s88, 1
    s_cmp_lt_u32 s88, 64
    s_cbranch_scc1 L_fb1_0
    v_mov_b32 v9, v8
    s_nop 1
    v_permlane32_swap_b32 v8, v9
    s_nop 1
    v_max_f32 v8, v8, v9
    v_sub_f32 v160, 0x80000000, v8
    v_sub_f32 v161, 0x80000000, v8
    v_mov_b64 v[162:163], v[160:161]
    v_mov_b64 v[164:165], v[160:161]
    v_mov_b64 v[166:167], v[160:161]
    v_mov_b64 v[168:169], v[160:161]
    v_mov_b64 v[170:171], v[160:161]
    v_mov_b64 v[172:173], v[160:161]
    v_mov_b64 v[174:175], v[160:161]
    v_mov_b64 v[112:113], 0
    v_mov_b64 v[114:115], 0
    v_mov_b64 v[116:117], 0
    v_mov_b64 v[118:119], 0
    v_mov_b64 v[120:121], 0
    v_mov_b64 v[122:123], 0
    v_mov_b64 v[124:125], 0
    v_mov_b64 v[126:127], 0
    s_mov_b32 s88, 0
L_fb2_0:
    s_lshr_b32 s50, s88, 3
    s_lshl_b32 s50, s50, 14
    s_and_b32 s51, s88, 7
    s_lshl_b32 s51, s51, 10
    s_add_u32 s50, s50, s51
    s_add_u32 s50, s50, s86
    buffer_load_dwordx4 v[144:147], v6, s[24:27], s50 offen sc1
    s_add_u32 s50, s50, 8192
    s_mov_b64 exec, s[44:45]
    buffer_load_dwordx4 v[148:151], v7, s[24:27], s50 offen sc1
    buffer_load_dwordx4 v[152:155], v7, s[24:27], s50 offen offset:512 sc1
    s_mov_b64 exec, -1
    s_waitcnt vmcnt(0)
    v_mfma_f32_32x32x16_bf16 v[176:191], v[144:147], v[84:87], v[160:175]
    s_nop 15
    v_exp_f32 v176, v176
    v_exp_f32 v177, v177
    v_exp_f32 v178, v178
    v_exp_f32 v179, v179
    v_exp_f32 v180, v180
    v_exp_f32 v181, v181
    v_exp_f32 v182, v182
    v_exp_f32 v183, v183
    v_exp_f32 v184, v184
    v_exp_f32 v185, v185
    v_exp_f32 v186, v186
    v_exp_f32 v187, v187
    v_exp_f32 v188, v188
    v_exp_f32 v189, v189
    v_exp_f32 v190, v190
    v_exp_f32 v191, v191
    s_nop 2
    v_smfmac_f32_32x32x32_bf16 v[112:127], v[148:151], v[176:183], v2
    v_smfmac_f32_32x32x32_bf16 v[112:127], v[152:155], v[184:191], v2
    s_nop 15
    s_add_u32 s88, s88, 1
    s_cmp_lt_u32 s88, 64
    s_cbranch_scc1 L_fb2_0
    v_mov_b32 v8, v120
    v_mov_b32 v9, v120
    s_nop 1
    v_permlane32_swap_b32 v8, v9
    s_nop 1
    s_branch L_fbret0
L_fallback1:
    s_lshl1_add_u32 s50, s4, s7
    s_lshl_b32 s86, s50, 17
    v_and_b32 v8, 31, v1
    v_cmp_eq_u32 vcc, 16, v8
    v_mov_b32 v9, 0x3f803f80
    s_nop 1
    v_cndmask_b32 v9, 0, v9, vcc
    v_mov_b32 v148, v9
    v_mov_b32 v149, v9
    v_mov_b32 v150, v9
    v_mov_b32 v151, v9
    v_mov_b32 v152, v9
    v_mov_b32 v153, v9
    v_mov_b32 v154, v9
    v_mov_b32 v155, v9
    v_mov_b32 v8, 0xff800000
    s_mov_b32 s88, 0
L_fb1_1:
    s_lshr_b32 s50, s88, 3
    s_lshl_b32 s50, s50, 14
    s_and_b32 s51, s88, 7
    s_lshl_b32 s51, s51, 10
    s_add_u32 s50, s50, s51
    s_add_u32 s50, s50, s86
    buffer_load_dwordx4 v[144:147], v6, s[24:27], s50 offen sc1
    s_waitcnt vmcnt(0)
    v_mfma_f32_32x32x16_bf16 v[176:191], v[144:147], v[80:83], 0
    s_nop 15
    v_max3_f32 v8, v8, v176, v177
    v_max3_f32 v8, v8, v178, v179
    v_max3_f32 v8, v8, v180, v181
    v_max3_f32 v8, v8, v182, v183
    v_max3_f32 v8, v8, v184, v185
    v_max3_f32 v8, v8, v186, v187
    v_max3_f32 v8, v8, v188, v189
    v_max3_f32 v8, v8, v190, v191
    s_add_u32 s88, s88, 1
    s_cmp_lt_u32 s88, 64
    s_cbranch_scc1 L_fb1_1
    v_mov_b32 v9, v8
    s_nop 1
    v_permlane32_swap_b32 v8, v9
    s_nop 1
    v_max_f32 v8, v8, v9
    v_sub_f32 v160, 0x80000000, v8
    v_sub_f32 v161, 0x80000000, v8
    v_mov_b64 v[162:163], v[160:161]
    v_mov_b64 v[164:165], v[160:161]
    v_mov_b64 v[166:167], v[160:161]
    v_mov_b64 v[168:169], v[160:161]
    v_mov_b64 v[170:171], v[160:161]
    v_mov_b64 v[172:173], v[160:161]
    v_mov_b64 v[174:175], v[160:161]
    v_mov_b64 v[48:49], 0
    v_mov_b64 v[50:51], 0
    v_mov_b64 v[52:53], 0
    v_mov_b64 v[54:55], 0
    v_mov_b64 v[56:57], 0
    v_mov_b64 v[58:59], 0
    v_mov_b64 v[60:61], 0
    v_mov_b64 v[62:63], 0
    s_mov_b32 s88, 0
L_fb2_1:
    s_lshr_b32 s50, s88, 3
    s_lshl_b32 s50, s50, 14
    s_and_b32 s51, s88, 7
    s_lshl_b32 s51, s51, 10
    s_add_u32 s50, s50, s51
    s_add_u32 s50, s50, s86
    buffer_load_dwordx4 v[144:147], v6, s[24:27], s50 offen sc1
    s_add_u32 s50, s50, 8192
    s_mov_b64 exec, s[44:45]
    buffer_load_dwordx4 v[148:151], v7, s[24:27], s50 offen sc1
    buffer_load_dwordx4 v[152:155], v7, s[24:27], s50 offen offset:512 sc1
    s_mov_b64 exec, -1
    s_waitcnt vmcnt(0)
    v_mfma_f32_32x32x16_bf16 v[176:191], v[144:147], v[80:83], v[160:175]
    s_nop 15
    v_exp_f32 v176, v176
    v_exp_f32 v177, v177
    v_exp_f32 v178, v178
    v_exp_f32 v179, v179
    v_exp_f32 v180, v180
    v_exp_f32 v181, v181
    v_exp_f32 v182, v182
    v_exp_f32 v183, v183
    v_exp_f32 v184, v184
    v_exp_f32 v185, v185
    v_exp_f32 v186, v186
    v_exp_f32 v187, v187
    v_exp_f32 v188, v188
    v_exp_f32 v189, v189
    v_exp_f32 v190, v190
    v_exp_f32 v191, v191
    s_nop 2
    v_smfmac_f32_32x32x32_bf16 v[48:63], v[148:151], v[176:183], v2
    v_smfmac_f32_32x32x32_bf16 v[48:63], v[152:155], v[184:191], v2
    s_nop 15
    s_add_u32 s88, s88, 1
    s_cmp_lt_u32 s88, 64
    s_cbranch_scc1 L_fb2_1
    v_mov_b32 v8, v56
    v_mov_b32 v9, v56
    s_nop 1
    v_permlane32_swap_b32 v8, v9
    s_nop 1
    s_branch L_fbret1
L_end:
    s_endpgm
L_codeend:
.section .rodata,"a"
.p2align 6
.amdhsa_kernel gated_mix__mha_block__grouped_kv_mqa__prompt_kernel
  .amdhsa_next_free_vgpr 256
  .amdhsa_next_free_sgpr 102
  .amdhsa_accum_offset 256
  .amdhsa_group_segment_fixed_size 0
  .amdhsa_kernarg_size 96
  .amdhsa_user_sgpr_count 2
  .amdhsa_user_sgpr_kernarg_segment_ptr 1
  .amdhsa_system_sgpr_workgroup_id_x 1
.end_amdhsa_kernel
```
